```python
import torch

def _softmax(x, axis=-1):
    return torch.softmax(x, dim=axis)
def _gelu(x):
    return torch.nn.functional.gelu(x, approximate="tanh")
def _silu(x):
    return torch.nn.functional.silu(x)
def _sigmoid(x):
    return torch.sigmoid(x)
def _layernorm(x, axis=-1, eps=1e-5):
    m = x.mean(dim=axis, keepdim=True)
    v = x.var(dim=axis, keepdim=True, unbiased=False)
    return (x - m) / torch.sqrt(v + eps)
def _scatter_add(tgt, idx, src, axis=0):
    return tgt.clone().index_add_(axis, idx, src)
def _segment_sum(src, seg, n):
    out = torch.zeros((n,) + src.shape[1:], dtype=src.dtype)
    return out.index_add_(0, seg, src)
def _pad(x, pw):
    flat = tuple(v for pair in reversed(pw) for v in pair)
    return torch.nn.functional.pad(x, flat)

kernel_name = 'interleave_layers__ssm_conv_h3__linear_attn_block__prompt'

def setup_inputs():

    _w = (lambda a: (lambda t: t.to(torch.bfloat16) if t.is_floating_point() else t)(torch.as_tensor(a)))
    def _A_setup():
        B, S, D = 1, 2048, 1024
        ks = 4
        return {
            "q": _w((lambda *s: torch.randn(*s, dtype=torch.bfloat16) * 0.05)(B, S, D)),
            "k": _w((lambda *s: torch.randn(*s, dtype=torch.bfloat16) * 0.4)(B, S, D)),
            "v": _w((lambda *s: torch.randn(*s, dtype=torch.bfloat16) * 0.4)(B, S, D)),
            "shift_k": _w((lambda *s: torch.randn(*s, dtype=torch.bfloat16) * 0.4)(D, ks) * 0.5),
            "ssm_k": _w((lambda *s: torch.randn(*s, dtype=torch.bfloat16) * 0.4)(D, S) * (1.0 / S ** 0.5)),
            "ssm_D": _w((lambda *s: torch.randn(*s, dtype=torch.bfloat16) * 0.4)(D)),
        }
    _A_in = _A_setup()

    def _B_setup():
        B, S, D = 1, 2048, 1024
        return {
            "x": _w((lambda *s: torch.randn(*s, dtype=torch.bfloat16) * 0.05)(B, S, D)),
            "wqkv": _w((lambda *s: torch.randn(*s, dtype=torch.bfloat16) * 0.1)(D, 3 * D)),
            "wo": _w((lambda *s: torch.randn(*s, dtype=torch.bfloat16) * 0.05)(D, D)),
        }
    _B_in = _B_setup()

    return {
        "A_q": _A_in["q"],
        "A_k": _A_in["k"],
        "A_v": _A_in["v"],
        "A_shift_k": _A_in["shift_k"],
        "A_ssm_k": _A_in["ssm_k"],
        "A_ssm_D": _A_in["ssm_D"],
        "B_x": _B_in["x"],
        "B_wqkv": _B_in["wqkv"],
        "B_wo": _B_in["wo"],
    }

def reference(A_q, A_k, A_v, A_shift_k, A_ssm_k, A_ssm_D, B_x, B_wqkv, B_wo):
    def _A_ref(q, k, v, shift_k, ssm_k, ssm_D):
        B, S, D = q.shape
        ks = shift_k.shape[-1]
        k_pad = _pad(k, ((0, 0), (ks - 1, 0), (0, 0)))
        k_shift = torch.zeros_like(k)
        for t in range(ks):
            k_shift = k_shift + k_pad[:, t:t + S, :] * shift_k[:, ks - 1 - t][None, None, :]
        kv = k_shift * v
        L = 2 * S
        kv_pad = _pad(kv, ((0, 0), (0, S), (0, 0)))
        kf_pad = _pad(ssm_k, ((0, 0), (0, S)))
        kv_f = (lambda x, axes=(-2,-1): torch.fft.rfft2(x.float(), dim=axes))(kv_pad[:, None, :, :], axes=(1, 2))
        kf_f = (lambda x, axes=(-2,-1): torch.fft.rfft2(x.float(), dim=axes))(kf_pad[:, None, :], axes=(1, 2))
        kf_f = (lambda x, *d: x.permute(*d))(kf_f, 1, 2, 0)
        y_f = kv_f * kf_f[None, :, :, :]
        y = (lambda x, s, axes=(-2,-1): torch.fft.irfft2(x, s=s, dim=axes).to(torch.bfloat16))(y_f, (1, L), axes=(1, 2))[:, 0, :S, :]
        y = y + kv * ssm_D[None, None, :]
        return q * y

    def _B_ref(x, wqkv, wo):
        B, S, D = x.shape
        H = 32; Dh = D // H
        qkv = (lambda x, *d: x.permute(*d))((x @ wqkv).reshape(B, S, 3, H, Dh), 2, 0, 3, 1, 4)
        q, k, v = qkv[0], qkv[1], qkv[2]
        phi = lambda t: torch.where(t > 0, t + 1, torch.exp(t)) + 1e-6
        pq, pk = phi(q), phi(k)
        kv = torch.einsum("bhsd,bhse->bhde", pk, v)
        z = torch.einsum("bhsd->bhd", pk)
        num = torch.einsum("bhqd,bhde->bhqe", pq, kv)
        den = torch.einsum("bhqd,bhd->bhq", pq, z)[..., None] + 1e-6
        o = num / den
        return (lambda x, *d: x.permute(*d))(o, 0, 2, 1, 3).reshape(B, S, D) @ wo

    x = A_q
    x = x + _A_ref(_layernorm(x, axis=-1), A_k, A_v, A_shift_k, A_ssm_k, A_ssm_D)
    x = x + _B_ref(_layernorm(x, axis=-1), B_wqkv, B_wo)
    x = x + _A_ref(_layernorm(x, axis=-1), A_k, A_v, A_shift_k, A_ssm_k, A_ssm_D)
    x = x + _B_ref(_layernorm(x, axis=-1), B_wqkv, B_wo)
    return x
```

```asm
; @launch grid=(256,1,1) block=(512,1,1) lds=163840
.amdgcn_target "amdgcn-amd-amdhsa--gfx950"
.text
.globl interleave_layers__ssm_conv_h3__linear_attn_block__prompt_kernel
.p2align 8
.type interleave_layers__ssm_conv_h3__linear_attn_block__prompt_kernel,@function
interleave_layers__ssm_conv_h3__linear_attn_block__prompt_kernel:
  s_cmp_ge_u32 s2, 256
  s_cbranch_scc1 L_done
  s_load_dwordx2 s[4:5], s[0:1], 8
  s_load_dwordx2 s[6:7], s[0:1], 16
  s_load_dwordx2 s[74:75], s[0:1], 24
  s_load_dwordx2 s[70:71], s[0:1], 88
  s_load_dwordx2 s[60:61], s[0:1], 0
  s_load_dwordx2 s[62:63], s[0:1], 32
  s_load_dwordx2 s[64:65], s[0:1], 56
  s_load_dwordx2 s[66:67], s[0:1], 64
  s_load_dwordx2 s[68:69], s[0:1], 72
  s_load_dwordx2 s[72:73], s[0:1], 80
  s_load_dwordx2 s[76:77], s[0:1], 40
  v_and_b32 v1, 63, v0
  v_lshrrev_b32 v5, 6, v0
  v_and_b32 v2, 31, v1
  v_lshrrev_b32 v3, 5, v1
  v_readfirstlane_b32 s50, v5
  s_and_b32 s78, s2, 7
  s_lshr_b32 s79, s2, 3
  s_and_b32 s80, s78, 1
  s_lshl_b32 s80, s80, 3
  s_and_b32 s81, s79, 7
  s_add_u32 s48, s80, s81
  s_lshr_b32 s80, s78, 1
  s_lshl_b32 s80, s80, 2
  s_lshr_b32 s81, s79, 3
  s_add_u32 s49, s80, s81
  v_and_b32 v32, 7, v0
  v_lshrrev_b32 v33, 3, v0
  s_lshl_b32 s78, s48, 18
  s_lshl_b32 s79, s49, 7
  s_add_u32 s78, s78, s79
  s_sub_u32 s78, s78, 6144
  v_lshlrev_b32 v34, 12, v33
  v_lshl_add_u32 v34, v32, 4, v34
  v_add_u32 v34, s78, v34
  v_add_u32 v35, 2048, v34
  v_add_u32 v36, 4096, v34
  v_add_u32 v37, 6144, v34
  v_add_u32 v38, 8192, v34
  s_lshl_b32 s79, s49, 9
  v_lshlrev_b32 v39, 6, v32
  v_add_u32 v39, s79, v39
  s_waitcnt lgkmcnt(0)
  s_mov_b32 s12, s4
  s_and_b32 s13, s5, 0xffff
  s_mov_b32 s14, 0x400000
  s_mov_b32 s15, 0x00020000
  s_mov_b32 s16, s6
  s_and_b32 s17, s7, 0xffff
  s_mov_b32 s18, 0x400000
  s_mov_b32 s19, 0x00020000
  s_mov_b32 s40, s74
  s_and_b32 s41, s75, 0xffff
  s_mov_b32 s42, 0x2000
  s_mov_b32 s43, 0x00020000
  buffer_load_dwordx4 v[40:43], v34, s[12:15], 0 offen
  buffer_load_dwordx4 v[44:47], v35, s[12:15], 0 offen
  buffer_load_dwordx4 v[48:51], v36, s[12:15], 0 offen
  buffer_load_dwordx4 v[52:55], v37, s[12:15], 0 offen
  buffer_load_dwordx4 v[56:59], v38, s[12:15], 0 offen
  buffer_load_dwordx4 v[60:63], v37, s[16:19], 0 offen
  buffer_load_dwordx4 v[64:67], v38, s[16:19], 0 offen
  buffer_load_dwordx4 v[68:71], v39, s[40:43], 0 offen offset:0
  buffer_load_dwordx4 v[72:75], v39, s[40:43], 0 offen offset:16
  buffer_load_dwordx4 v[76:79], v39, s[40:43], 0 offen offset:32
  buffer_load_dwordx4 v[80:83], v39, s[40:43], 0 offen offset:48
  s_mov_b32 s8, s70
  s_and_b32 s9, s71, 0xffff
  s_mov_b32 s10, 0x10000000
  s_mov_b32 s11, 0x00020000
  s_mov_b32 s20, s60
  s_and_b32 s21, s61, 0xffff
  s_mov_b32 s22, 0x400000
  s_mov_b32 s23, 0x00020000
  s_mov_b32 s24, s62
  s_and_b32 s25, s63, 0xffff
  s_mov_b32 s26, 0x400000
  s_mov_b32 s27, 0x00020000
  s_mov_b32 s28, s64
  s_and_b32 s29, s65, 0xffff
  s_mov_b32 s30, 0x600000
  s_mov_b32 s31, 0x00020000
  s_mov_b32 s32, s66
  s_and_b32 s33, s67, 0xffff
  s_mov_b32 s34, 0x200000
  s_mov_b32 s35, 0x00020000
  s_mov_b32 s36, s68
  s_and_b32 s37, s69, 0xffff
  s_mov_b32 s38, 0x400000
  s_mov_b32 s39, 0x00020000
  s_mov_b32 s44, s72
  s_and_b32 s45, s73, 0xffff
  s_mov_b32 s46, 0x100
  s_mov_b32 s47, 0x00020000
  s_mov_b32 s84, s76
  s_and_b32 s85, s77, 0xffff
  s_mov_b32 s86, 0x800
  s_mov_b32 s87, 0x00020000
  s_and_b32 s51, s50, 1
  s_bfe_u32 s52, s50, 0x10001
  s_mov_b32 s53, 0
  s_lshl_b32 s78, s48, 8
  s_add_u32 s58, s78, 0x2300000
  s_lshl_b32 s78, s49, 8
  s_add_u32 s59, s78, 0x2310000
  s_mov_b32 s54, 0x800000
  s_mov_b32 s55, 0x1f00000
  s_mov_b32 s56, 0x1800000
  s_mov_b32 s57, 0x1000000
  s_cmp_eq_u32 s50, 7
  s_cbranch_scc0 L_noinit
  v_cmp_gt_u32 vcc, 8, v1
  s_and_saveexec_b64 s[90:91], vcc
  v_lshlrev_b32 v5, 12, v1
  v_mov_b32 v6, 0
  v_mov_b32 v7, 1
  s_cmp_eq_u32 s49, 0
  s_cbranch_scc0 L_init2
  buffer_store_dword v6, v5, s[8:11], s58 offen sc1
  s_waitcnt vmcnt(0)
  s_lshl_b32 s60, s48, 2
  v_mov_b32 v8, s60
  buffer_store_dword v7, v8, s[44:47], 0 offen sc1
L_init2:
  s_cmp_eq_u32 s48, 0
  s_cbranch_scc0 L_init3
  buffer_store_dword v6, v5, s[8:11], s59 offen sc1
  s_waitcnt vmcnt(0)
  s_lshl_b32 s60, s49, 2
  s_add_u32 s60, s60, 64
  v_mov_b32 v8, s60
  buffer_store_dword v7, v8, s[44:47], 0 offen sc1
L_init3:
  s_mov_b64 exec, s[90:91]
L_noinit:
  v_bfe_u32 v8, v2, 1, 3
  s_lshl_b32 s60, s52, 2
  v_add_u32 v9, s60, v3
  v_xor_b32 v8, v8, v9
  v_lshlrev_b32 v8, 4, v8
  v_lshl_add_u32 v8, v2, 7, v8
  s_lshl_b32 s60, s51, 13
  v_add_u32 v26, s60, v8
  v_sub_u32 v5, 63, v33
  v_lshlrev_b32 v6, 2, v32
  v_xor_b32 v5, v5, v6
  v_lshlrev_b32 v5, 2, v5
  v_lshl_add_u32 v5, v32, 11, v5
  v_add_u32 v5, 65536, v5
  s_waitcnt vmcnt(0)
  v_lshlrev_b32 v96, 16, v40
  v_and_b32 v97, 0xffff0000, v40
  v_lshlrev_b32 v98, 16, v44
  v_and_b32 v99, 0xffff0000, v44
  v_lshlrev_b32 v100, 16, v48
  v_and_b32 v101, 0xffff0000, v48
  v_lshlrev_b32 v102, 16, v52
  v_and_b32 v103, 0xffff0000, v52
  v_lshlrev_b32 v104, 16, v56
  v_and_b32 v105, 0xffff0000, v56
  v_lshlrev_b32 v106, 16, v60
  v_and_b32 v107, 0xffff0000, v60
  v_lshlrev_b32 v108, 16, v64
  v_and_b32 v109, 0xffff0000, v64
  v_lshlrev_b32 v110, 16, v68
  v_lshlrev_b32 v111, 16, v70
  v_and_b32 v112, 0xffff0000, v68
  v_and_b32 v113, 0xffff0000, v70
  v_lshlrev_b32 v114, 16, v69
  v_lshlrev_b32 v115, 16, v71
  v_and_b32 v116, 0xffff0000, v69
  v_and_b32 v117, 0xffff0000, v71
  v_pk_mul_f32 v[144:145], v[96:97], v[116:117]
  v_pk_mul_f32 v[146:147], v[98:99], v[116:117]
  v_pk_fma_f32 v[144:145], v[98:99], v[114:115], v[144:145]
  v_pk_fma_f32 v[146:147], v[100:101], v[114:115], v[146:147]
  v_pk_fma_f32 v[144:145], v[100:101], v[112:113], v[144:145]
  v_pk_fma_f32 v[146:147], v[102:103], v[112:113], v[146:147]
  v_pk_fma_f32 v[144:145], v[102:103], v[110:111], v[144:145]
  v_pk_fma_f32 v[146:147], v[104:105], v[110:111], v[146:147]
  v_pk_mul_f32 v[144:145], v[144:145], v[106:107]
  v_pk_mul_f32 v[146:147], v[146:147], v[108:109]
  v_cvt_pk_bf16_f32 v152, v146, v144
  v_cvt_pk_bf16_f32 v153, v147, v145
  ds_write_b32 v5, v152 offset:0
  ds_write_b32 v5, v153 offset:256
  v_lshlrev_b32 v120, 16, v41
  v_and_b32 v121, 0xffff0000, v41
  v_lshlrev_b32 v122, 16, v45
  v_and_b32 v123, 0xffff0000, v45
  v_lshlrev_b32 v124, 16, v49
  v_and_b32 v125, 0xffff0000, v49
  v_lshlrev_b32 v126, 16, v53
  v_and_b32 v127, 0xffff0000, v53
  v_lshlrev_b32 v128, 16, v57
  v_and_b32 v129, 0xffff0000, v57
  v_lshlrev_b32 v130, 16, v61
  v_and_b32 v131, 0xffff0000, v61
  v_lshlrev_b32 v132, 16, v65
  v_and_b32 v133, 0xffff0000, v65
  v_lshlrev_b32 v134, 16, v72
  v_lshlrev_b32 v135, 16, v74
  v_and_b32 v136, 0xffff0000, v72
  v_and_b32 v137, 0xffff0000, v74
  v_lshlrev_b32 v138, 16, v73
  v_lshlrev_b32 v139, 16, v75
  v_and_b32 v140, 0xffff0000, v73
  v_and_b32 v141, 0xffff0000, v75
  v_pk_mul_f32 v[148:149], v[120:121], v[140:141]
  v_pk_mul_f32 v[150:151], v[122:123], v[140:141]
  v_pk_fma_f32 v[148:149], v[122:123], v[138:139], v[148:149]
  v_pk_fma_f32 v[150:151], v[124:125], v[138:139], v[150:151]
  v_pk_fma_f32 v[148:149], v[124:125], v[136:137], v[148:149]
  v_pk_fma_f32 v[150:151], v[126:127], v[136:137], v[150:151]
  v_pk_fma_f32 v[148:149], v[126:127], v[134:135], v[148:149]
  v_pk_fma_f32 v[150:151], v[128:129], v[134:135], v[150:151]
  v_pk_mul_f32 v[148:149], v[148:149], v[130:131]
  v_pk_mul_f32 v[150:151], v[150:151], v[132:133]
  v_cvt_pk_bf16_f32 v154, v150, v148
  v_cvt_pk_bf16_f32 v155, v151, v149
  ds_write_b32 v5, v154 offset:512
  ds_write_b32 v5, v155 offset:768
  v_lshlrev_b32 v96, 16, v42
  v_and_b32 v97, 0xffff0000, v42
  v_lshlrev_b32 v98, 16, v46
  v_and_b32 v99, 0xffff0000, v46
  v_lshlrev_b32 v100, 16, v50
  v_and_b32 v101, 0xffff0000, v50
  v_lshlrev_b32 v102, 16, v54
  v_and_b32 v103, 0xffff0000, v54
  v_lshlrev_b32 v104, 16, v58
  v_and_b32 v105, 0xffff0000, v58
  v_lshlrev_b32 v106, 16, v62
  v_and_b32 v107, 0xffff0000, v62
  v_lshlrev_b32 v108, 16, v66
  v_and_b32 v109, 0xffff0000, v66
  v_lshlrev_b32 v110, 16, v76
  v_lshlrev_b32 v111, 16, v78
  v_and_b32 v112, 0xffff0000, v76
  v_and_b32 v113, 0xffff0000, v78
  v_lshlrev_b32 v114, 16, v77
  v_lshlrev_b32 v115, 16, v79
  v_and_b32 v116, 0xffff0000, v77
  v_and_b32 v117, 0xffff0000, v79
  v_pk_mul_f32 v[144:145], v[96:97], v[116:117]
  v_pk_mul_f32 v[146:147], v[98:99], v[116:117]
  v_pk_fma_f32 v[144:145], v[98:99], v[114:115], v[144:145]
  v_pk_fma_f32 v[146:147], v[100:101], v[114:115], v[146:147]
  v_pk_fma_f32 v[144:145], v[100:101], v[112:113], v[144:145]
  v_pk_fma_f32 v[146:147], v[102:103], v[112:113], v[146:147]
  v_pk_fma_f32 v[144:145], v[102:103], v[110:111], v[144:145]
  v_pk_fma_f32 v[146:147], v[104:105], v[110:111], v[146:147]
  v_pk_mul_f32 v[144:145], v[144:145], v[106:107]
  v_pk_mul_f32 v[146:147], v[146:147], v[108:109]
  v_cvt_pk_bf16_f32 v152, v146, v144
  v_cvt_pk_bf16_f32 v153, v147, v145
  ds_write_b32 v5, v152 offset:1024
  ds_write_b32 v5, v153 offset:1280
  v_lshlrev_b32 v120, 16, v43
  v_and_b32 v121, 0xffff0000, v43
  v_lshlrev_b32 v122, 16, v47
  v_and_b32 v123, 0xffff0000, v47
  v_lshlrev_b32 v124, 16, v51
  v_and_b32 v125, 0xffff0000, v51
  v_lshlrev_b32 v126, 16, v55
  v_and_b32 v127, 0xffff0000, v55
  v_lshlrev_b32 v128, 16, v59
  v_and_b32 v129, 0xffff0000, v59
  v_lshlrev_b32 v130, 16, v63
  v_and_b32 v131, 0xffff0000, v63
  v_lshlrev_b32 v132, 16, v67
  v_and_b32 v133, 0xffff0000, v67
  v_lshlrev_b32 v134, 16, v80
  v_lshlrev_b32 v135, 16, v82
  v_and_b32 v136, 0xffff0000, v80
  v_and_b32 v137, 0xffff0000, v82
  v_lshlrev_b32 v138, 16, v81
  v_lshlrev_b32 v139, 16, v83
  v_and_b32 v140, 0xffff0000, v81
  v_and_b32 v141, 0xffff0000, v83
  v_pk_mul_f32 v[148:149], v[120:121], v[140:141]
  v_pk_mul_f32 v[150:151], v[122:123], v[140:141]
  v_pk_fma_f32 v[148:149], v[122:123], v[138:139], v[148:149]
  v_pk_fma_f32 v[150:151], v[124:125], v[138:139], v[150:151]
  v_pk_fma_f32 v[148:149], v[124:125], v[136:137], v[148:149]
  v_pk_fma_f32 v[150:151], v[126:127], v[136:137], v[150:151]
  v_pk_fma_f32 v[148:149], v[126:127], v[134:135], v[148:149]
  v_pk_fma_f32 v[150:151], v[128:129], v[134:135], v[150:151]
  v_pk_mul_f32 v[148:149], v[148:149], v[130:131]
  v_pk_mul_f32 v[150:151], v[150:151], v[132:133]
  v_cvt_pk_bf16_f32 v154, v150, v148
  v_cvt_pk_bf16_f32 v155, v151, v149
  ds_write_b32 v5, v154 offset:1536
  ds_write_b32 v5, v155 offset:1792
  s_waitcnt lgkmcnt(0)
  s_barrier
  v_lshrrev_b32 v6, 4, v1
  v_and_b32 v7, 15, v1
  s_lshl_b32 s60, s50, 3
  v_add_u32 v6, s60, v6
  v_mov_b32 v8, s50
  v_xor_b32 v8, v8, v7
  v_lshlrev_b32 v8, 4, v8
  v_lshl_add_u32 v8, v6, 8, v8
  v_add_u32 v8, 65536, v8
  ds_read_b128 v[40:43], v8
  ds_read_b128 v[44:47], v8 offset:1024
  s_lshl_b32 s61, s49, 18
  s_add_u32 s62, s48, 1
  s_lshl_b32 s62, s62, 8
  s_sub_u32 s62, 4096, s62
  s_add_u32 s61, s61, s62
  s_add_u32 s62, s61, 16384
  v_lshlrev_b32 v9, 12, v6
  v_lshl_add_u32 v9, v7, 4, v9
  s_waitcnt lgkmcnt(1)
  buffer_store_dwordx4 v[40:43], v9, s[8:11], s61 offen sc1
  s_waitcnt lgkmcnt(0)
  buffer_store_dwordx4 v[44:47], v9, s[8:11], s62 offen sc1
  s_cmp_ge_u32 s50, 4
  s_cbranch_scc1 L_helper
  s_waitcnt vmcnt(0)
  s_barrier
  s_lshl_b32 s70, s49, 6
  s_lshl_b32 s71, s48, 2
  s_add_u32 s70, s70, s71
  s_add_u32 s70, s70, s50
  s_lshl_b32 s71, s70, 12
  s_mul_i32 s72, s50, 12928
  v_lshlrev_b32 v6, 4, v1
  buffer_load_dwordx4 v[128:131], v6, s[24:27], s71 offen offset:0
  buffer_load_dwordx4 v[132:135], v6, s[24:27], s71 offen offset:1024
  buffer_load_dwordx4 v[136:139], v6, s[24:27], s71 offen offset:2048
  buffer_load_dwordx4 v[140:143], v6, s[24:27], s71 offen offset:3072
  buffer_load_dword v144, v6, s[24:27], s71 offen offset:16
  buffer_load_dword v145, v6, s[24:27], s71 offen offset:1040
  buffer_load_dword v146, v6, s[24:27], s71 offen offset:2064
  buffer_load_dword v147, v6, s[24:27], s71 offen offset:3088
  s_lshl_b32 s65, s70, 1
  v_mov_b32 v150, s65
  buffer_load_ushort v148, v150, s[84:87], 0 offen
  v_lshlrev_b32 v4, 11, v2
  v_lshl_add_u32 v4, v3, 4, v4
  s_lshl_b32 s60, s48, 18
  s_lshl_b32 s61, s51, 17
  s_add_u32 s60, s60, s61
  s_lshl_b32 s61, s49, 7
  s_add_u32 s60, s60, s61
  s_lshl_b32 s61, s52, 6
  s_add_u32 s68, s60, s61
  s_add_u32 s69, s68, 0x10000
  v_bfe_u32 v27, v2, 1, 3
  v_xor_b32 v27, v27, v3
  v_lshlrev_b32 v27, 4, v27
  v_lshl_add_u32 v27, v2, 7, v27
  s_lshl_b32 s60, s51, 13
  v_add_u32 v27, s60, v27
  v_bfe_u32 v13, v1, 4, 1
  v_bfe_u32 v14, v1, 2, 2
  v_and_b32 v15, 3, v1
  v_lshlrev_b32 v28, 1, v13
  v_lshrrev_b32 v13, 1, v15
  v_add_u32 v28, v28, v13
  s_lshl_b32 s60, s52, 2
  v_add_u32 v28, s60, v28
  v_bfe_u32 v13, v14, 1, 1
  v_lshlrev_b32 v13, 2, v13
  v_xor_b32 v28, v28, v13
  v_lshlrev_b32 v28, 4, v28
  v_and_b32 v13, 1, v15
  v_lshl_add_u32 v28, v13, 3, v28
  v_lshl_add_u32 v13, v3, 3, v14
  v_lshl_add_u32 v28, v13, 7, v28
  v_add_u32 v7, s72, v6
  v_mov_b32 v88, 0
  v_mov_b32 v89, 0
  v_mov_b32 v90, 0
  v_mov_b32 v91, 0
  v_cmp_gt_u32 vcc, 2, v1
  s_and_saveexec_b64 s[90:91], vcc
  ds_write_b128 v7, v[88:91] offset:0
  ds_write_b128 v7, v[88:91] offset:4160
  s_mov_b64 exec, s[90:91]
  v_cmp_gt_u32 vcc, 30, v1
  s_and_saveexec_b64 s[90:91], vcc
  ds_write_b128 v7, v[88:91] offset:12416
  s_mov_b64 exec, s[90:91]
  v_and_b32 v5, 15, v1
  v_lshrrev_b32 v13, 4, v1
  v_lshrrev_b32 v8, 1, v5
  v_lshl_add_u32 v8, v13, 2, v8
  v_lshlrev_b32 v8, 2, v8
  v_and_b32 v9, 1, v5
  v_mov_b32 v10, 4160
  v_mov_b32 v11, 4
  v_cmp_eq_u32 vcc, 1, v9
  s_nop 1
  v_cndmask_b32 v10, v10, v11, vcc
  v_add_u32 v8, v8, v10
  v_add_u32 v8, s72, v8
  v_add_u32 v9, 1024, v8
  v_add_u32 v10, 2048, v8
  v_add_u32 v11, 3072, v8
  v_lshlrev_b32 v12, 4, v13
  v_lshlrev_b32 v14, 5, v5
  v_sub_u32 v12, v12, v14
  v_add_u32 v12, 8800, v12
  v_add_u32 v12, s72, v12
  v_mov_b32 v32, 0
  v_mov_b32 v33, 0
  v_mov_b32 v34, 0
  v_mov_b32 v35, 0
  v_mov_b32 v36, 0
  v_mov_b32 v37, 0
  v_mov_b32 v38, 0
  v_mov_b32 v39, 0
  v_mov_b32 v40, 0
  v_mov_b32 v41, 0
  v_mov_b32 v42, 0
  v_mov_b32 v43, 0
  v_mov_b32 v44, 0
  v_mov_b32 v45, 0
  v_mov_b32 v46, 0
  v_mov_b32 v47, 0
  v_mov_b32 v48, 0
  v_mov_b32 v49, 0
  v_mov_b32 v50, 0
  v_mov_b32 v51, 0
  v_mov_b32 v52, 0
  v_mov_b32 v53, 0
  v_mov_b32 v54, 0
  v_mov_b32 v55, 0
  v_mov_b32 v56, 0
  v_mov_b32 v57, 0
  v_mov_b32 v58, 0
  v_mov_b32 v59, 0
  v_mov_b32 v60, 0
  v_mov_b32 v61, 0
  v_mov_b32 v62, 0
  v_mov_b32 v63, 0
  s_waitcnt vmcnt(0)
  ds_write_b128 v7, v[128:131] offset:32
  ds_write_b128 v7, v[132:135] offset:1056
  ds_write_b128 v7, v[136:139] offset:2080
  ds_write_b128 v7, v[140:143] offset:3104
  v_alignbit_b32 v92, v129, v128, 16
  v_alignbit_b32 v93, v130, v129, 16
  v_alignbit_b32 v94, v131, v130, 16
  v_alignbit_b32 v95, v144, v131, 16
  ds_write_b128 v7, v[92:95] offset:4192
  v_alignbit_b32 v96, v133, v132, 16
  v_alignbit_b32 v97, v134, v133, 16
  v_alignbit_b32 v98, v135, v134, 16
  v_alignbit_b32 v99, v145, v135, 16
  ds_write_b128 v7, v[96:99] offset:5216
  v_alignbit_b32 v92, v137, v136, 16
  v_alignbit_b32 v93, v138, v137, 16
  v_alignbit_b32 v94, v139, v138, 16
  v_alignbit_b32 v95, v146, v139, 16
  ds_write_b128 v7, v[92:95] offset:6240
  v_alignbit_b32 v96, v141, v140, 16
  v_alignbit_b32 v97, v142, v141, 16
  v_alignbit_b32 v98, v143, v142, 16
  v_alignbit_b32 v99, v147, v143, 16
  ds_write_b128 v7, v[96:99] offset:7264
  v_lshlrev_b32 v88, 16, v128
  v_cmp_eq_u32 vcc, 0, v1
  s_and_saveexec_b64 s[90:91], vcc
  ds_write_b32 v7, v88 offset:4188
  s_mov_b64 exec, s[90:91]
  v_lshlrev_b32 v30, 16, v148
  s_barrier
  buffer_load_dwordx4 v[64:67], v6, s[8:11], s71 offen offset:0 sc1
  buffer_load_dwordx4 v[68:71], v6, s[8:11], s71 offen offset:1024 sc1
  buffer_load_dwordx4 v[72:75], v6, s[8:11], s71 offen offset:2048 sc1
  buffer_load_dwordx4 v[76:79], v6, s[8:11], s71 offen offset:3072 sc1
  s_waitcnt vmcnt(0)
  s_barrier
  ds_write_b128 v7, v[64:67] offset:8320
  ds_write_b128 v7, v[68:71] offset:9344
  ds_write_b128 v7, v[72:75] offset:10368
  ds_write_b128 v7, v[76:79] offset:11392
  buffer_load_dwordx4 v[224:227], v4, s[20:23], s68 offen offset:0
  buffer_load_dwordx4 v[228:231], v4, s[20:23], s68 offen offset:32
  buffer_load_dwordx4 v[232:235], v4, s[20:23], s69 offen offset:0
  buffer_load_dwordx4 v[236:239], v4, s[20:23], s69 offen offset:32
  s_waitcnt lgkmcnt(0)
  ds_read_b128 v[96:99], v12 offset:3584
  ds_read2_b32 v[64:65], v8 offset0:0 offset1:1
  ds_read2_b32 v[66:67], v8 offset0:2 offset1:3
  ds_read_b128 v[100:103], v12 offset:3072
  ds_read2_b32 v[68:69], v8 offset0:128 offset1:129
  ds_read2_b32 v[70:71], v8 offset0:130 offset1:131
  ds_read_b128 v[104:107], v12 offset:2560
  ds_read2_b32 v[72:73], v9 offset0:0 offset1:1
  ds_read2_b32 v[74:75], v9 offset0:2 offset1:3
  ds_read_b128 v[108:111], v12 offset:2048
  ds_read2_b32 v[76:77], v9 offset0:128 offset1:129
  ds_read2_b32 v[78:79], v9 offset0:130 offset1:131
  ds_read_b128 v[112:115], v12 offset:1536
  ds_read2_b32 v[80:81], v10 offset0:0 offset1:1
  ds_read2_b32 v[82:83], v10 offset0:2 offset1:3
  ds_read_b128 v[116:119], v12 offset:1024
  ds_read2_b32 v[84:85], v10 offset0:128 offset1:129
  ds_read2_b32 v[86:87], v10 offset0:130 offset1:131
  ds_read_b128 v[120:123], v12 offset:512
  ds_read2_b32 v[88:89], v11 offset0:0 offset1:1
  ds_read2_b32 v[90:91], v11 offset0:2 offset1:3
  ds_read_b128 v[124:127], v12 offset:0
  ds_read2_b32 v[92:93], v11 offset0:128 offset1:129
  ds_read2_b32 v[94:95], v11 offset0:130 offset1:131
  s_mov_b32 s65, 0
  .p2align 6
L_conv:
  s_waitcnt lgkmcnt(0)
  v_mfma_f32_16x16x32_bf16 v[32:35], v[64:67], v[96:99], v[32:35]
  ds_read_b128 v[160:163], v12 offset:3648
  v_mfma_f32_16x16x32_bf16 v[36:39], v[64:67], v[100:103], v[36:39]
  ds_read2_b32 v[128:129], v8 offset0:16 offset1:17
  v_mfma_f32_16x16x32_bf16 v[40:43], v[64:67], v[104:107], v[40:43]
  ds_read2_b32 v[130:131], v8 offset0:18 offset1:19
  v_mfma_f32_16x16x32_bf16 v[44:47], v[64:67], v[108:111], v[44:47]
  ds_read_b128 v[164:167], v12 offset:3136
  v_mfma_f32_16x16x32_bf16 v[48:51], v[64:67], v[112:115], v[48:51]
  ds_read2_b32 v[132:133], v8 offset0:144 offset1:145
  v_mfma_f32_16x16x32_bf16 v[52:55], v[64:67], v[116:119], v[52:55]
  ds_read2_b32 v[134:135], v8 offset0:146 offset1:147
  v_mfma_f32_16x16x32_bf16 v[56:59], v[64:67], v[120:123], v[56:59]
  ds_read_b128 v[168:171], v12 offset:2624
  v_mfma_f32_16x16x32_bf16 v[60:63], v[64:67], v[124:127], v[60:63]
  ds_read2_b32 v[136:137], v9 offset0:16 offset1:17
  v_mfma_f32_16x16x32_bf16 v[36:39], v[68:71], v[96:99], v[36:39]
  ds_read2_b32 v[138:139], v9 offset0:18 offset1:19
  v_mfma_f32_16x16x32_bf16 v[40:43], v[68:71], v[100:103], v[40:43]
  ds_read_b128 v[172:175], v12 offset:2112
  v_mfma_f32_16x16x32_bf16 v[44:47], v[68:71], v[104:107], v[44:47]
  ds_read2_b32 v[140:141], v9 offset0:144 offset1:145
  v_mfma_f32_16x16x32_bf16 v[48:51], v[68:71], v[108:111], v[48:51]
  ds_read2_b32 v[142:143], v9 offset0:146 offset1:147
  v_mfma_f32_16x16x32_bf16 v[52:55], v[68:71], v[112:115], v[52:55]
  ds_read_b128 v[176:179], v12 offset:1600
  v_mfma_f32_16x16x32_bf16 v[56:59], v[68:71], v[116:119], v[56:59]
  ds_read2_b32 v[144:145], v10 offset0:16 offset1:17
  v_mfma_f32_16x16x32_bf16 v[60:63], v[68:71], v[120:123], v[60:63]
  ds_read2_b32 v[146:147], v10 offset0:18 offset1:19
  v_mfma_f32_16x16x32_bf16 v[40:43], v[72:75], v[96:99], v[40:43]
  ds_read_b128 v[180:183], v12 offset:1088
  v_mfma_f32_16x16x32_bf16 v[44:47], v[72:75], v[100:103], v[44:47]
  ds_read2_b32 v[148:149], v10 offset0:144 offset1:145
  v_mfma_f32_16x16x32_bf16 v[48:51], v[72:75], v[104:107], v[48:51]
  ds_read2_b32 v[150:151], v10 offset0:146 offset1:147
  v_mfma_f32_16x16x32_bf16 v[52:55], v[72:75], v[108:111], v[52:55]
  ds_read_b128 v[184:187], v12 offset:576
  v_mfma_f32_16x16x32_bf16 v[56:59], v[72:75], v[112:115], v[56:59]
  ds_read2_b32 v[152:153], v11 offset0:16 offset1:17
  v_mfma_f32_16x16x32_bf16 v[60:63], v[72:75], v[116:119], v[60:63]
  ds_read2_b32 v[154:155], v11 offset0:18 offset1:19
  v_mfma_f32_16x16x32_bf16 v[44:47], v[76:79], v[96:99], v[44:47]
  ds_read_b128 v[188:191], v12 offset:64
  v_mfma_f32_16x16x32_bf16 v[48:51], v[76:79], v[100:103], v[48:51]
  ds_read2_b32 v[156:157], v11 offset0:144 offset1:145
  v_mfma_f32_16x16x32_bf16 v[52:55], v[76:79], v[104:107], v[52:55]
  ds_read2_b32 v[158:159], v11 offset0:146 offset1:147
  v_mfma_f32_16x16x32_bf16 v[56:59], v[76:79], v[108:111], v[56:59]
  v_mfma_f32_16x16x32_bf16 v[60:63], v[76:79], v[112:115], v[60:63]
  v_mfma_f32_16x16x32_bf16 v[48:51], v[80:83], v[96:99], v[48:51]
  v_mfma_f32_16x16x32_bf16 v[52:55], v[80:83], v[100:103], v[52:55]
  v_mfma_f32_16x16x32_bf16 v[56:59], v[80:83], v[104:107], v[56:59]
  v_mfma_f32_16x16x32_bf16 v[60:63], v[80:83], v[108:111], v[60:63]
  v_mfma_f32_16x16x32_bf16 v[52:55], v[84:87], v[96:99], v[52:55]
  v_mfma_f32_16x16x32_bf16 v[56:59], v[84:87], v[100:103], v[56:59]
  v_mfma_f32_16x16x32_bf16 v[60:63], v[84:87], v[104:107], v[60:63]
  v_mfma_f32_16x16x32_bf16 v[56:59], v[88:91], v[96:99], v[56:59]
  v_mfma_f32_16x16x32_bf16 v[60:63], v[88:91], v[100:103], v[60:63]
  v_mfma_f32_16x16x32_bf16 v[60:63], v[92:95], v[96:99], v[60:63]
  s_waitcnt lgkmcnt(0)
  v_mfma_f32_16x16x32_bf16 v[32:35], v[128:131], v[160:163], v[32:35]
  ds_read_b128 v[96:99], v12 offset:3712
  v_mfma_f32_16x16x32_bf16 v[36:39], v[128:131], v[164:167], v[36:39]
  ds_read2_b32 v[64:65], v8 offset0:32 offset1:33
  v_mfma_f32_16x16x32_bf16 v[40:43], v[128:131], v[168:171], v[40:43]
  ds_read2_b32 v[66:67], v8 offset0:34 offset1:35
  v_mfma_f32_16x16x32_bf16 v[44:47], v[128:131], v[172:175], v[44:47]
  ds_read_b128 v[100:103], v12 offset:3200
  v_mfma_f32_16x16x32_bf16 v[48:51], v[128:131], v[176:179], v[48:51]
  ds_read2_b32 v[68:69], v8 offset0:160 offset1:161
  v_mfma_f32_16x16x32_bf16 v[52:55], v[128:131], v[180:183], v[52:55]
  ds_read2_b32 v[70:71], v8 offset0:162 offset1:163
  v_mfma_f32_16x16x32_bf16 v[56:59], v[128:131], v[184:187], v[56:59]
  ds_read_b128 v[104:107], v12 offset:2688
  v_mfma_f32_16x16x32_bf16 v[60:63], v[128:131], v[188:191], v[60:63]
  ds_read2_b32 v[72:73], v9 offset0:32 offset1:33
  v_mfma_f32_16x16x32_bf16 v[36:39], v[132:135], v[160:163], v[36:39]
  ds_read2_b32 v[74:75], v9 offset0:34 offset1:35
  v_mfma_f32_16x16x32_bf16 v[40:43], v[132:135], v[164:167], v[40:43]
  ds_read_b128 v[108:111], v12 offset:2176
  v_mfma_f32_16x16x32_bf16 v[44:47], v[132:135], v[168:171], v[44:47]
  ds_read2_b32 v[76:77], v9 offset0:160 offset1:161
  v_mfma_f32_16x16x32_bf16 v[48:51], v[132:135], v[172:175], v[48:51]
  ds_read2_b32 v[78:79], v9 offset0:162 offset1:163
  v_mfma_f32_16x16x32_bf16 v[52:55], v[132:135], v[176:179], v[52:55]
  ds_read_b128 v[112:115], v12 offset:1664
  v_mfma_f32_16x16x32_bf16 v[56:59], v[132:135], v[180:183], v[56:59]
  ds_read2_b32 v[80:81], v10 offset0:32 offset1:33
  v_mfma_f32_16x16x32_bf16 v[60:63], v[132:135], v[184:187], v[60:63]
  ds_read2_b32 v[82:83], v10 offset0:34 offset1:35
  v_mfma_f32_16x16x32_bf16 v[40:43], v[136:139], v[160:163], v[40:43]
  ds_read_b128 v[116:119], v12 offset:1152
  v_mfma_f32_16x16x32_bf16 v[44:47], v[136:139], v[164:167], v[44:47]
  ds_read2_b32 v[84:85], v10 offset0:160 offset1:161
  v_mfma_f32_16x16x32_bf16 v[48:51], v[136:139], v[168:171], v[48:51]
  ds_read2_b32 v[86:87], v10 offset0:162 offset1:163
  v_mfma_f32_16x16x32_bf16 v[52:55], v[136:139], v[172:175], v[52:55]
  ds_read_b128 v[120:123], v12 offset:640
  v_mfma_f32_16x16x32_bf16 v[56:59], v[136:139], v[176:179], v[56:59]
  ds_read2_b32 v[88:89], v11 offset0:32 offset1:33
  v_mfma_f32_16x16x32_bf16 v[60:63], v[136:139], v[180:183], v[60:63]
  ds_read2_b32 v[90:91], v11 offset0:34 offset1:35
  v_mfma_f32_16x16x32_bf16 v[44:47], v[140:143], v[160:163], v[44:47]
  ds_read_b128 v[124:127], v12 offset:128
  v_mfma_f32_16x16x32_bf16 v[48:51], v[140:143], v[164:167], v[48:51]
  ds_read2_b32 v[92:93], v11 offset0:160 offset1:161
  v_mfma_f32_16x16x32_bf16 v[52:55], v[140:143], v[168:171], v[52:55]
  ds_read2_b32 v[94:95], v11 offset0:162 offset1:163
  v_mfma_f32_16x16x32_bf16 v[56:59], v[140:143], v[172:175], v[56:59]
  v_mfma_f32_16x16x32_bf16 v[60:63], v[140:143], v[176:179], v[60:63]
  v_mfma_f32_16x16x32_bf16 v[48:51], v[144:147], v[160:163], v[48:51]
  v_mfma_f32_16x16x32_bf16 v[52:55], v[144:147], v[164:167], v[52:55]
  v_mfma_f32_16x16x32_bf16 v[56:59], v[144:147], v[168:171], v[56:59]
  v_mfma_f32_16x16x32_bf16 v[60:63], v[144:147], v[172:175], v[60:63]
  v_mfma_f32_16x16x32_bf16 v[52:55], v[148:151], v[160:163], v[52:55]
  v_mfma_f32_16x16x32_bf16 v[56:59], v[148:151], v[164:167], v[56:59]
  v_mfma_f32_16x16x32_bf16 v[60:63], v[148:151], v[168:171], v[60:63]
  v_mfma_f32_16x16x32_bf16 v[56:59], v[152:155], v[160:163], v[56:59]
  v_mfma_f32_16x16x32_bf16 v[60:63], v[152:155], v[164:167], v[60:63]
  v_mfma_f32_16x16x32_bf16 v[60:63], v[156:159], v[160:163], v[60:63]
  v_add_u32 v8, 128, v8
  v_add_u32 v9, 128, v9
  v_add_u32 v10, 128, v10
  v_add_u32 v11, 128, v11
  v_add_u32 v12, 128, v12
  s_add_u32 s65, s65, 1
  s_cmp_lt_u32 s65, 4
  s_cbranch_scc1 L_conv
  s_waitcnt lgkmcnt(0)
  v_lshlrev_b32 v12, 3, v13
  v_add_u32 v12, v12, v14
  v_sub_u32 v8, 8824, v12
  v_add_u32 v8, s72, v8
  ds_read_b64 v[64:65], v8 offset:3584
  ds_read_b64 v[66:67], v8 offset:3072
  ds_read_b64 v[68:69], v8 offset:2560
  ds_read_b64 v[70:71], v8 offset:2048
  ds_read_b64 v[72:73], v8 offset:1536
  ds_read_b64 v[74:75], v8 offset:1024
  ds_read_b64 v[76:77], v8 offset:512
  ds_read_b64 v[78:79], v8 offset:0
  s_add_u32 s65, s71, 0x400000
  v_add_u32 v13, s72, v12
  s_waitcnt lgkmcnt(0)
  v_and_b32 v96, 0xffff0000, v65
  v_lshlrev_b32 v97, 16, v65
  v_and_b32 v98, 0xffff0000, v64
  v_lshlrev_b32 v99, 16, v64
  v_pk_fma_f32 v[96:97], v[96:97], v[30:31], v[32:33] op_sel_hi:[1,0,1]
  v_pk_fma_f32 v[98:99], v[98:99], v[30:31], v[34:35] op_sel_hi:[1,0,1]
  v_cvt_pk_bf16_f32 v108, v96, v97
  v_cvt_pk_bf16_f32 v109, v98, v99
  ds_write_b64 v13, v[108:109] offset:0
  v_and_b32 v112, 0xffff0000, v67
  v_lshlrev_b32 v113, 16, v67
  v_and_b32 v114, 0xffff0000, v66
  v_lshlrev_b32 v115, 16, v66
  v_pk_fma_f32 v[112:113], v[112:113], v[30:31], v[36:37] op_sel_hi:[1,0,1]
  v_pk_fma_f32 v[114:115], v[114:115], v[30:31], v[38:39] op_sel_hi:[1,0,1]
  v_cvt_pk_bf16_f32 v124, v112, v113
  v_cvt_pk_bf16_f32 v125, v114, v115
  ds_write_b64 v13, v[124:125] offset:512
  v_and_b32 v96, 0xffff0000, v69
  v_lshlrev_b32 v97, 16, v69
  v_and_b32 v98, 0xffff0000, v68
  v_lshlrev_b32 v99, 16, v68
  v_pk_fma_f32 v[96:97], v[96:97], v[30:31], v[40:41] op_sel_hi:[1,0,1]
  v_pk_fma_f32 v[98:99], v[98:99], v[30:31], v[42:43] op_sel_hi:[1,0,1]
  v_cvt_pk_bf16_f32 v108, v96, v97
  v_cvt_pk_bf16_f32 v109, v98, v99
  ds_write_b64 v13, v[108:109] offset:1024
  v_and_b32 v112, 0xffff0000, v71
  v_lshlrev_b32 v113, 16, v71
  v_and_b32 v114, 0xffff0000, v70
  v_lshlrev_b32 v115, 16, v70
  v_pk_fma_f32 v[112:113], v[112:113], v[30:31], v[44:45] op_sel_hi:[1,0,1]
  v_pk_fma_f32 v[114:115], v[114:115], v[30:31], v[46:47] op_sel_hi:[1,0,1]
  v_cvt_pk_bf16_f32 v124, v112, v113
  v_cvt_pk_bf16_f32 v125, v114, v115
  ds_write_b64 v13, v[124:125] offset:1536
  v_and_b32 v96, 0xffff0000, v73
  v_lshlrev_b32 v97, 16, v73
  v_and_b32 v98, 0xffff0000, v72
  v_lshlrev_b32 v99, 16, v72
  v_pk_fma_f32 v[96:97], v[96:97], v[30:31], v[48:49] op_sel_hi:[1,0,1]
  v_pk_fma_f32 v[98:99], v[98:99], v[30:31], v[50:51] op_sel_hi:[1,0,1]
  v_cvt_pk_bf16_f32 v108, v96, v97
  v_cvt_pk_bf16_f32 v109, v98, v99
  ds_write_b64 v13, v[108:109] offset:2048
  v_and_b32 v112, 0xffff0000, v75
  v_lshlrev_b32 v113, 16, v75
  v_and_b32 v114, 0xffff0000, v74
  v_lshlrev_b32 v115, 16, v74
  v_pk_fma_f32 v[112:113], v[112:113], v[30:31], v[52:53] op_sel_hi:[1,0,1]
  v_pk_fma_f32 v[114:115], v[114:115], v[30:31], v[54:55] op_sel_hi:[1,0,1]
  v_cvt_pk_bf16_f32 v124, v112, v113
  v_cvt_pk_bf16_f32 v125, v114, v115
  ds_write_b64 v13, v[124:125] offset:2560
  v_and_b32 v96, 0xffff0000, v77
  v_lshlrev_b32 v97, 16, v77
  v_and_b32 v98, 0xffff0000, v76
  v_lshlrev_b32 v99, 16, v76
  v_pk_fma_f32 v[96:97], v[96:97], v[30:31], v[56:57] op_sel_hi:[1,0,1]
  v_pk_fma_f32 v[98:99], v[98:99], v[30:31], v[58:59] op_sel_hi:[1,0,1]
  v_cvt_pk_bf16_f32 v108, v96, v97
  v_cvt_pk_bf16_f32 v109, v98, v99
  ds_write_b64 v13, v[108:109] offset:3072
  v_and_b32 v112, 0xffff0000, v79
  v_lshlrev_b32 v113, 16, v79
  v_and_b32 v114, 0xffff0000, v78
  v_lshlrev_b32 v115, 16, v78
  v_pk_fma_f32 v[112:113], v[112:113], v[30:31], v[60:61] op_sel_hi:[1,0,1]
  v_pk_fma_f32 v[114:115], v[114:115], v[30:31], v[62:63] op_sel_hi:[1,0,1]
  v_cvt_pk_bf16_f32 v124, v112, v113
  v_cvt_pk_bf16_f32 v125, v114, v115
  ds_write_b64 v13, v[124:125] offset:3584
  v_lshlrev_b32 v6, 4, v1
  v_add_u32 v7, s72, v6
  s_waitcnt lgkmcnt(0)
  ds_read_b128 v[64:67], v7 offset:0
  ds_read_b128 v[68:71], v7 offset:1024
  ds_read_b128 v[72:75], v7 offset:2048
  ds_read_b128 v[76:79], v7 offset:3072
  s_waitcnt lgkmcnt(3)
  buffer_store_dwordx4 v[64:67], v6, s[8:11], s65 offen offset:0 sc1
  s_waitcnt lgkmcnt(2)
  buffer_store_dwordx4 v[68:71], v6, s[8:11], s65 offen offset:1024 sc1
  s_waitcnt lgkmcnt(1)
  buffer_store_dwordx4 v[72:75], v6, s[8:11], s65 offen offset:2048 sc1
  s_waitcnt lgkmcnt(0)
  buffer_store_dwordx4 v[76:79], v6, s[8:11], s65 offen offset:3072 sc1
  s_waitcnt vmcnt(0)
  s_barrier
  s_barrier
  s_lshl_b32 s60, s48, 14
  s_lshl_b32 s61, s51, 9
  s_add_u32 s60, s60, s61
  s_add_u32 s60, s60, 0x1e00000
  v_lshlrev_b32 v5, 13, v3
  v_lshl_add_u32 v5, v2, 3, v5
  buffer_load_dwordx2 v[64:65], v5, s[8:11], s60 offen offset:0 sc1
  buffer_load_dwordx2 v[80:81], v5, s[8:11], s60 offen offset:256 sc1
  s_add_u32 s60, s60, 1024
  buffer_load_dwordx2 v[66:67], v5, s[8:11], s60 offen offset:0 sc1
  buffer_load_dwordx2 v[82:83], v5, s[8:11], s60 offen offset:256 sc1
  s_add_u32 s60, s60, 1024
  buffer_load_dwordx2 v[68:69], v5, s[8:11], s60 offen offset:0 sc1
  buffer_load_dwordx2 v[84:85], v5, s[8:11], s60 offen offset:256 sc1
  s_add_u32 s60, s60, 1024
  buffer_load_dwordx2 v[70:71], v5, s[8:11], s60 offen offset:0 sc1
  buffer_load_dwordx2 v[86:87], v5, s[8:11], s60 offen offset:256 sc1
  s_add_u32 s60, s60, 1024
  buffer_load_dwordx2 v[72:73], v5, s[8:11], s60 offen offset:0 sc1
  buffer_load_dwordx2 v[88:89], v5, s[8:11], s60 offen offset:256 sc1
  s_add_u32 s60, s60, 1024
  buffer_load_dwordx2 v[74:75], v5, s[8:11], s60 offen offset:0 sc1
  buffer_load_dwordx2 v[90:91], v5, s[8:11], s60 offen offset:256 sc1
  s_add_u32 s60, s60, 1024
  buffer_load_dwordx2 v[76:77], v5, s[8:11], s60 offen offset:0 sc1
  buffer_load_dwordx2 v[92:93], v5, s[8:11], s60 offen offset:256 sc1
  s_add_u32 s60, s60, 1024
  buffer_load_dwordx2 v[78:79], v5, s[8:11], s60 offen offset:0 sc1
  buffer_load_dwordx2 v[94:95], v5, s[8:11], s60 offen offset:256 sc1
  s_mul_i32 s60, s49, 12288
  s_add_u32 s60, s60, 0x2200000
  s_lshl_b32 s61, s52, 7
  s_add_u32 s60, s60, s61
  v_lshlrev_b32 v5, 2, v2
  v_mul_u32_u24 v6, 6144, v3
  v_add_u32 v5, v5, v6
  buffer_load_dword v96, v5, s[8:11], s60 offen offset:0 sc1
  buffer_load_dword v97, v5, s[8:11], s60 offen offset:256 sc1
  buffer_load_dword v98, v5, s[8:11], s60 offen offset:512 sc1
  s_add_u32 s60, s60, 768
  buffer_load_dword v99, v5, s[8:11], s60 offen offset:0 sc1
  buffer_load_dword v100, v5, s[8:11], s60 offen offset:256 sc1
  buffer_load_dword v101, v5, s[8:11], s60 offen offset:512 sc1
  s_add_u32 s60, s60, 768
  buffer_load_dword v102, v5, s[8:11], s60 offen offset:0 sc1
  buffer_load_dword v103, v5, s[8:11], s60 offen offset:256 sc1
  buffer_load_dword v104, v5, s[8:11], s60 offen offset:512 sc1
  s_add_u32 s60, s60, 768
  buffer_load_dword v105, v5, s[8:11], s60 offen offset:0 sc1
  buffer_load_dword v106, v5, s[8:11], s60 offen offset:256 sc1
  buffer_load_dword v107, v5, s[8:11], s60 offen offset:512 sc1
  s_add_u32 s60, s60, 768
  buffer_load_dword v108, v5, s[8:11], s60 offen offset:0 sc1
  buffer_load_dword v109, v5, s[8:11], s60 offen offset:256 sc1
  buffer_load_dword v110, v5, s[8:11], s60 offen offset:512 sc1
  s_add_u32 s60, s60, 768
  buffer_load_dword v111, v5, s[8:11], s60 offen offset:0 sc1
  buffer_load_dword v112, v5, s[8:11], s60 offen offset:256 sc1
  buffer_load_dword v113, v5, s[8:11], s60 offen offset:512 sc1
  s_add_u32 s60, s60, 768
  buffer_load_dword v114, v5, s[8:11], s60 offen offset:0 sc1
  buffer_load_dword v115, v5, s[8:11], s60 offen offset:256 sc1
  buffer_load_dword v116, v5, s[8:11], s60 offen offset:512 sc1
  s_add_u32 s60, s60, 768
  buffer_load_dword v117, v5, s[8:11], s60 offen offset:0 sc1
  buffer_load_dword v118, v5, s[8:11], s60 offen offset:256 sc1
  buffer_load_dword v119, v5, s[8:11], s60 offen offset:512 sc1
  v_bfe_u32 v5, v1, 2, 2
  v_lshl_add_u32 v5, v3, 3, v5
  v_lshlrev_b32 v5, 8, v5
  v_bfe_u32 v6, v1, 4, 1
  v_lshl_add_u32 v5, v6, 5, v5
  v_and_b32 v6, 3, v1
  v_lshl_add_u32 v5, v6, 3, v5
  s_lshl_b32 s60, s52, 13
  s_lshl_b32 s61, s51, 7
  s_add_u32 s60, s60, s61
  v_add_u32 v5, s60, v5
  s_waitcnt vmcnt(24)
  v_pk_add_f32 v[64:65], v[64:65], v[66:67]
  v_pk_add_f32 v[80:81], v[80:81], v[82:83]
  v_pk_add_f32 v[64:65], v[64:65], v[68:69]
  v_pk_add_f32 v[80:81], v[80:81], v[84:85]
  v_pk_add_f32 v[64:65], v[64:65], v[70:71]
  v_pk_add_f32 v[80:81], v[80:81], v[86:87]
  v_pk_add_f32 v[64:65], v[64:65], v[72:73]
  v_pk_add_f32 v[80:81], v[80:81], v[88:89]
  v_pk_add_f32 v[64:65], v[64:65], v[74:75]
  v_pk_add_f32 v[80:81], v[80:81], v[90:91]
  v_pk_add_f32 v[64:65], v[64:65], v[76:77]
  v_pk_add_f32 v[80:81], v[80:81], v[92:93]
  v_pk_add_f32 v[64:65], v[64:65], v[78:79]
  v_pk_add_f32 v[80:81], v[80:81], v[94:95]
  v_mov_b32 v66, v64
  v_mov_b32 v67, v65
  v_mov_b32 v82, v80
  v_mov_b32 v83, v81
  s_mov_b32 s60, 0x3a800000
  s_mov_b32 s61, 0x3727c5ac
  v_permlane32_swap_b32 v66, v64
  v_permlane32_swap_b32 v67, v65
  v_permlane32_swap_b32 v82, v80
  v_permlane32_swap_b32 v83, v81
  s_nop 0
  v_pk_add_f32 v[64:65], v[64:65], v[66:67]
  v_pk_add_f32 v[80:81], v[80:81], v[82:83]
  v_mul_f32 v16, s60, v64
  v_mul_f32 v65, s60, v65
  v_mul_f32 v18, s60, v80
  v_mul_f32 v81, s60, v81
  v_fma_f32 v65, -v16, v16, v65
  v_max_f32 v65, 0, v65
  v_add_f32 v65, s61, v65
  v_rsq_f32 v20, v65
  v_fma_f32 v81, -v18, v18, v81
  v_max_f32 v81, 0, v81
  v_add_f32 v81, s61, v81
  v_rsq_f32 v22, v81
  s_nop 0
  s_barrier
  ds_read_b64_tr_b16 v[240:241], v5 offset:0
  ds_read_b64_tr_b16 v[242:243], v5 offset:1024
  ds_read_b64_tr_b16 v[244:245], v5 offset:4096
  ds_read_b64_tr_b16 v[246:247], v5 offset:5120
  ds_read_b64_tr_b16 v[248:249], v5 offset:64
  ds_read_b64_tr_b16 v[250:251], v5 offset:1088
  ds_read_b64_tr_b16 v[252:253], v5 offset:4160
  ds_read_b64_tr_b16 v[254:255], v5 offset:5184
  s_waitcnt vmcnt(0)
  v_add_f32 v96, v96, v99
  v_add_f32 v96, v96, v102
  v_add_f32 v96, v96, v105
  v_add_f32 v96, v96, v108
  v_add_f32 v96, v96, v111
  v_add_f32 v96, v96, v114
  v_add_f32 v96, v96, v117
  v_add_f32 v97, v97, v100
  v_add_f32 v97, v97, v103
  v_add_f32 v97, v97, v106
  v_add_f32 v97, v97, v109
  v_add_f32 v97, v97, v112
  v_add_f32 v97, v97, v115
  v_add_f32 v97, v97, v118
  v_add_f32 v98, v98, v101
  v_add_f32 v98, v98, v104
  v_add_f32 v98, v98, v107
  v_add_f32 v98, v98, v110
  v_add_f32 v98, v98, v113
  v_add_f32 v98, v98, v116
  v_add_f32 v98, v98, v119
  v_mov_b32 v100, v96
  v_mov_b32 v101, v97
  v_mov_b32 v102, v98
  s_nop 1
  v_permlane32_swap_b32 v100, v96
  v_permlane32_swap_b32 v101, v97
  v_permlane32_swap_b32 v102, v98
  s_nop 1
  v_add_f32 v17, v96, v100
  v_add_f32 v19, v97, v101
  v_add_f32 v21, v98, v102
  s_waitcnt lgkmcnt(0)
L_etail:
  v_lshlrev_b32 v56, 16, v224
  v_and_b32 v57, 0xffff0000, v224
  v_lshlrev_b32 v58, 16, v240
  v_and_b32 v59, 0xffff0000, v240
  v_pk_add_f32 v[60:61], v[56:57], v[16:17] op_sel_hi:[1,0] neg_lo:[0,1] neg_hi:[0,1]
  v_pk_mul_f32 v[60:61], v[60:61], v[20:21] op_sel_hi:[1,0]
  v_pk_fma_f32 v[56:57], v[60:61], v[58:59], v[56:57]
  v_pk_mul_f32 v[50:51], v[56:57], v[56:57]
  v_mov_b32 v48, v56
  v_mov_b32 v49, v57
  v_cvt_pk_bf16_f32 v224, v56, v57
  v_lshlrev_b32 v62, 16, v232
  v_and_b32 v63, 0xffff0000, v232
  v_lshlrev_b32 v64, 16, v248
  v_and_b32 v65, 0xffff0000, v248
  v_pk_add_f32 v[66:67], v[62:63], v[18:19] op_sel_hi:[1,0] neg_lo:[0,1] neg_hi:[0,1]
  v_pk_mul_f32 v[66:67], v[66:67], v[22:23] op_sel_hi:[1,0]
  v_pk_fma_f32 v[62:63], v[66:67], v[64:65], v[62:63]
  v_pk_mul_f32 v[54:55], v[62:63], v[62:63]
  v_mov_b32 v52, v62
  v_mov_b32 v53, v63
  v_cvt_pk_bf16_f32 v232, v62, v63
  v_lshlrev_b32 v68, 16, v225
  v_and_b32 v69, 0xffff0000, v225
  v_lshlrev_b32 v70, 16, v241
  v_and_b32 v71, 0xffff0000, v241
  v_pk_add_f32 v[72:73], v[68:69], v[16:17] op_sel_hi:[1,0] neg_lo:[0,1] neg_hi:[0,1]
  v_pk_mul_f32 v[72:73], v[72:73], v[20:21] op_sel_hi:[1,0]
  v_pk_fma_f32 v[68:69], v[72:73], v[70:71], v[68:69]
  v_pk_fma_f32 v[50:51], v[68:69], v[68:69], v[50:51]
  v_pk_add_f32 v[48:49], v[48:49], v[68:69]
  v_cvt_pk_bf16_f32 v225, v68, v69
  v_lshlrev_b32 v74, 16, v233
  v_and_b32 v75, 0xffff0000, v233
  v_lshlrev_b32 v76, 16, v249
  v_and_b32 v77, 0xffff0000, v249
  v_pk_add_f32 v[78:79], v[74:75], v[18:19] op_sel_hi:[1,0] neg_lo:[0,1] neg_hi:[0,1]
  v_pk_mul_f32 v[78:79], v[78:79], v[22:23] op_sel_hi:[1,0]
  v_pk_fma_f32 v[74:75], v[78:79], v[76:77], v[74:75]
  v_pk_fma_f32 v[54:55], v[74:75], v[74:75], v[54:55]
  v_pk_add_f32 v[52:53], v[52:53], v[74:75]
  v_cvt_pk_bf16_f32 v233, v74, v75
  v_lshlrev_b32 v56, 16, v226
  v_and_b32 v57, 0xffff0000, v226
  v_lshlrev_b32 v58, 16, v242
  v_and_b32 v59, 0xffff0000, v242
  v_pk_add_f32 v[60:61], v[56:57], v[16:17] op_sel_hi:[1,0] neg_lo:[0,1] neg_hi:[0,1]
  v_pk_mul_f32 v[60:61], v[60:61], v[20:21] op_sel_hi:[1,0]
  v_pk_fma_f32 v[56:57], v[60:61], v[58:59], v[56:57]
  v_pk_fma_f32 v[50:51], v[56:57], v[56:57], v[50:51]
  v_pk_add_f32 v[48:49], v[48:49], v[56:57]
  v_cvt_pk_bf16_f32 v226, v56, v57
  v_lshlrev_b32 v62, 16, v234
  v_and_b32 v63, 0xffff0000, v234
  v_lshlrev_b32 v64, 16, v250
  v_and_b32 v65, 0xffff0000, v250
  v_pk_add_f32 v[66:67], v[62:63], v[18:19] op_sel_hi:[1,0] neg_lo:[0,1] neg_hi:[0,1]
  v_pk_mul_f32 v[66:67], v[66:67], v[22:23] op_sel_hi:[1,0]
  v_pk_fma_f32 v[62:63], v[66:67], v[64:65], v[62:63]
  v_pk_fma_f32 v[54:55], v[62:63], v[62:63], v[54:55]
  v_pk_add_f32 v[52:53], v[52:53], v[62:63]
  v_cvt_pk_bf16_f32 v234, v62, v63
  v_lshlrev_b32 v68, 16, v227
  v_and_b32 v69, 0xffff0000, v227
  v_lshlrev_b32 v70, 16, v243
  v_and_b32 v71, 0xffff0000, v243
  v_pk_add_f32 v[72:73], v[68:69], v[16:17] op_sel_hi:[1,0] neg_lo:[0,1] neg_hi:[0,1]
  v_pk_mul_f32 v[72:73], v[72:73], v[20:21] op_sel_hi:[1,0]
  v_pk_fma_f32 v[68:69], v[72:73], v[70:71], v[68:69]
  v_pk_fma_f32 v[50:51], v[68:69], v[68:69], v[50:51]
  v_pk_add_f32 v[48:49], v[48:49], v[68:69]
  v_cvt_pk_bf16_f32 v227, v68, v69
  v_lshlrev_b32 v74, 16, v235
  v_and_b32 v75, 0xffff0000, v235
  v_lshlrev_b32 v76, 16, v251
  v_and_b32 v77, 0xffff0000, v251
  v_pk_add_f32 v[78:79], v[74:75], v[18:19] op_sel_hi:[1,0] neg_lo:[0,1] neg_hi:[0,1]
  v_pk_mul_f32 v[78:79], v[78:79], v[22:23] op_sel_hi:[1,0]
  v_pk_fma_f32 v[74:75], v[78:79], v[76:77], v[74:75]
  v_pk_fma_f32 v[54:55], v[74:75], v[74:75], v[54:55]
  v_pk_add_f32 v[52:53], v[52:53], v[74:75]
  v_cvt_pk_bf16_f32 v235, v74, v75
  v_lshlrev_b32 v56, 16, v228
  v_and_b32 v57, 0xffff0000, v228
  v_lshlrev_b32 v58, 16, v244
  v_and_b32 v59, 0xffff0000, v244
  v_pk_add_f32 v[60:61], v[56:57], v[16:17] op_sel_hi:[1,0] neg_lo:[0,1] neg_hi:[0,1]
  v_pk_mul_f32 v[60:61], v[60:61], v[20:21] op_sel_hi:[1,0]
  v_pk_fma_f32 v[56:57], v[60:61], v[58:59], v[56:57]
  v_pk_fma_f32 v[50:51], v[56:57], v[56:57], v[50:51]
  v_pk_add_f32 v[48:49], v[48:49], v[56:57]
  v_cvt_pk_bf16_f32 v228, v56, v57
  v_lshlrev_b32 v62, 16, v236
  v_and_b32 v63, 0xffff0000, v236
  v_lshlrev_b32 v64, 16, v252
  v_and_b32 v65, 0xffff0000, v252
  v_pk_add_f32 v[66:67], v[62:63], v[18:19] op_sel_hi:[1,0] neg_lo:[0,1] neg_hi:[0,1]
  v_pk_mul_f32 v[66:67], v[66:67], v[22:23] op_sel_hi:[1,0]
  v_pk_fma_f32 v[62:63], v[66:67], v[64:65], v[62:63]
  v_pk_fma_f32 v[54:55], v[62:63], v[62:63], v[54:55]
  v_pk_add_f32 v[52:53], v[52:53], v[62:63]
  v_cvt_pk_bf16_f32 v236, v62, v63
  v_lshlrev_b32 v68, 16, v229
  v_and_b32 v69, 0xffff0000, v229
  v_lshlrev_b32 v70, 16, v245
  v_and_b32 v71, 0xffff0000, v245
  v_pk_add_f32 v[72:73], v[68:69], v[16:17] op_sel_hi:[1,0] neg_lo:[0,1] neg_hi:[0,1]
  v_pk_mul_f32 v[72:73], v[72:73], v[20:21] op_sel_hi:[1,0]
  v_pk_fma_f32 v[68:69], v[72:73], v[70:71], v[68:69]
  v_pk_fma_f32 v[50:51], v[68:69], v[68:69], v[50:51]
  v_pk_add_f32 v[48:49], v[48:49], v[68:69]
  v_cvt_pk_bf16_f32 v229, v68, v69
  v_lshlrev_b32 v74, 16, v237
  v_and_b32 v75, 0xffff0000, v237
  v_lshlrev_b32 v76, 16, v253
  v_and_b32 v77, 0xffff0000, v253
  v_pk_add_f32 v[78:79], v[74:75], v[18:19] op_sel_hi:[1,0] neg_lo:[0,1] neg_hi:[0,1]
  v_pk_mul_f32 v[78:79], v[78:79], v[22:23] op_sel_hi:[1,0]
  v_pk_fma_f32 v[74:75], v[78:79], v[76:77], v[74:75]
  v_pk_fma_f32 v[54:55], v[74:75], v[74:75], v[54:55]
  v_pk_add_f32 v[52:53], v[52:53], v[74:75]
  v_cvt_pk_bf16_f32 v237, v74, v75
  v_lshlrev_b32 v56, 16, v230
  v_and_b32 v57, 0xffff0000, v230
  v_lshlrev_b32 v58, 16, v246
  v_and_b32 v59, 0xffff0000, v246
  v_pk_add_f32 v[60:61], v[56:57], v[16:17] op_sel_hi:[1,0] neg_lo:[0,1] neg_hi:[0,1]
  v_pk_mul_f32 v[60:61], v[60:61], v[20:21] op_sel_hi:[1,0]
  v_pk_fma_f32 v[56:57], v[60:61], v[58:59], v[56:57]
  v_pk_fma_f32 v[50:51], v[56:57], v[56:57], v[50:51]
  v_pk_add_f32 v[48:49], v[48:49], v[56:57]
  v_cvt_pk_bf16_f32 v230, v56, v57
  v_lshlrev_b32 v62, 16, v238
  v_and_b32 v63, 0xffff0000, v238
  v_lshlrev_b32 v64, 16, v254
  v_and_b32 v65, 0xffff0000, v254
  v_pk_add_f32 v[66:67], v[62:63], v[18:19] op_sel_hi:[1,0] neg_lo:[0,1] neg_hi:[0,1]
  v_pk_mul_f32 v[66:67], v[66:67], v[22:23] op_sel_hi:[1,0]
  v_pk_fma_f32 v[62:63], v[66:67], v[64:65], v[62:63]
  v_pk_fma_f32 v[54:55], v[62:63], v[62:63], v[54:55]
  v_pk_add_f32 v[52:53], v[52:53], v[62:63]
  v_cvt_pk_bf16_f32 v238, v62, v63
  v_lshlrev_b32 v68, 16, v231
  v_and_b32 v69, 0xffff0000, v231
  v_lshlrev_b32 v70, 16, v247
  v_and_b32 v71, 0xffff0000, v247
  v_pk_add_f32 v[72:73], v[68:69], v[16:17] op_sel_hi:[1,0] neg_lo:[0,1] neg_hi:[0,1]
  v_pk_mul_f32 v[72:73], v[72:73], v[20:21] op_sel_hi:[1,0]
  v_pk_fma_f32 v[68:69], v[72:73], v[70:71], v[68:69]
  v_pk_fma_f32 v[50:51], v[68:69], v[68:69], v[50:51]
  v_pk_add_f32 v[48:49], v[48:49], v[68:69]
  v_cvt_pk_bf16_f32 v231, v68, v69
  v_lshlrev_b32 v74, 16, v239
  v_and_b32 v75, 0xffff0000, v239
  v_lshlrev_b32 v76, 16, v255
  v_and_b32 v77, 0xffff0000, v255
  v_pk_add_f32 v[78:79], v[74:75], v[18:19] op_sel_hi:[1,0] neg_lo:[0,1] neg_hi:[0,1]
  v_pk_mul_f32 v[78:79], v[78:79], v[22:23] op_sel_hi:[1,0]
  v_pk_fma_f32 v[74:75], v[78:79], v[76:77], v[74:75]
  v_pk_fma_f32 v[54:55], v[74:75], v[74:75], v[54:55]
  v_pk_add_f32 v[52:53], v[52:53], v[74:75]
  v_cvt_pk_bf16_f32 v239, v74, v75
  v_add_u32 v5, 81920, v26
  v_xor_b32 v6, 32, v5
  ds_write_b128 v5, v[224:227] offset:0
  ds_write_b128 v6, v[228:231] offset:0
  ds_write_b128 v5, v[232:235] offset:4096
  ds_write_b128 v6, v[236:239] offset:4096
  v_add_f32 v40, v48, v49
  v_add_f32 v41, v50, v51
  v_add_f32 v42, v52, v53
  v_add_f32 v43, v54, v55
  v_mov_b32 v44, v40
  v_mov_b32 v45, v41
  v_mov_b32 v46, v42
  v_mov_b32 v47, v43
  s_lshl_b32 s60, s51, 9
  s_lshl_b32 s61, s52, 10
  v_permlane32_swap_b32 v44, v40
  v_permlane32_swap_b32 v45, v41
  v_permlane32_swap_b32 v46, v42
  v_permlane32_swap_b32 v47, v43
  v_cmp_eq_u32 vcc, 1, v3
  s_add_u32 s60, s60, s61
  s_add_u32 s60, s60, 57344
  v_add_f32 v40, v40, v44
  v_add_f32 v41, v41, v45
  v_add_f32 v42, v42, v46
  v_add_f32 v43, v43, v47
  v_cndmask_b32 v48, v40, v42, vcc
  v_cndmask_b32 v49, v41, v43, vcc
  v_lshlrev_b32 v7, 3, v1
  v_add_u32 v7, s60, v7
  ds_write_b64 v7, v[48:49]
  v_add_u32 v8, 81920, v27
  v_xor_b32 v9, 32, v8
  v_xor_b32 v10, 64, v8
  v_xor_b32 v11, 96, v8
  v_add_u32 v12, 98304, v28
  s_mov_b32 s62, 40960
  s_mov_b32 s63, 0
  s_mov_b32 s64, 2
  s_waitcnt lgkmcnt(0)
  s_barrier
  ds_read_b128 v[32:35], v8 offset:0
  ds_read_b128 v[36:39], v8 offset:4096
  ds_read_b64_tr_b16 v[40:41], v12 offset:0
  ds_read_b64_tr_b16 v[42:43], v12 offset:512
  ds_read_b64_tr_b16 v[44:45], v12 offset:8192
  ds_read_b64_tr_b16 v[46:47], v12 offset:8704
  ds_read_b64_tr_b16 v[48:49], v12 offset:16384
  ds_read_b64_tr_b16 v[50:51], v12 offset:16896
  s_waitcnt lgkmcnt(0)
  v_mfma_f32_32x32x16_bf16 v[128:143], v[40:43], v[32:35], 0
  ds_read_b128 v[52:55], v9 offset:0
  ds_read_b128 v[56:59], v9 offset:4096
  v_mfma_f32_32x32x16_bf16 v[160:175], v[32:35], v[44:47], 0
  ds_read_b64_tr_b16 v[60:61], v12 offset:2048
  ds_read_b64_tr_b16 v[62:63], v12 offset:2560
  v_mfma_f32_32x32x16_bf16 v[192:207], v[32:35], v[48:51], 0
  ds_read_b64_tr_b16 v[64:65], v12 offset:10240
  ds_read_b64_tr_b16 v[66:67], v12 offset:10752
  v_mfma_f32_32x32x16_bf16 v[144:159], v[40:43], v[36:39], 0
  ds_read_b64_tr_b16 v[68:69], v12 offset:18432
  ds_read_b64_tr_b16 v[70:71], v12 offset:18944
  v_mfma_f32_32x32x16_bf16 v[176:191], v[36:39], v[44:47], 0
  v_mfma_f32_32x32x16_bf16 v[208:223], v[36:39], v[48:51], 0
  .p2align 6
L_g1loop:
  s_waitcnt lgkmcnt(0)
  v_mfma_f32_32x32x16_bf16 v[128:143], v[60:63], v[52:55], v[128:143]
  ds_read_b128 v[32:35], v10 offset:0
  ds_read_b128 v[36:39], v10 offset:4096
  v_mfma_f32_32x32x16_bf16 v[160:175], v[52:55], v[64:67], v[160:175]
  ds_read_b64_tr_b16 v[40:41], v12 offset:4096
  ds_read_b64_tr_b16 v[42:43], v12 offset:4608
  v_mfma_f32_32x32x16_bf16 v[192:207], v[52:55], v[68:71], v[192:207]
  ds_read_b64_tr_b16 v[44:45], v12 offset:12288
  ds_read_b64_tr_b16 v[46:47], v12 offset:12800
  v_mfma_f32_32x32x16_bf16 v[144:159], v[60:63], v[56:59], v[144:159]
  ds_read_b64_tr_b16 v[48:49], v12 offset:20480
  ds_read_b64_tr_b16 v[50:51], v12 offset:20992
  v_mfma_f32_32x32x16_bf16 v[176:191], v[56:59], v[64:67], v[176:191]
  v_mfma_f32_32x32x16_bf16 v[208:223], v[56:59], v[68:71], v[208:223]
  s_waitcnt lgkmcnt(0)
  v_mfma_f32_32x32x16_bf16 v[128:143], v[40:43], v[32:35], v[128:143]
  ds_read_b128 v[52:55], v11 offset:0
  ds_read_b128 v[56:59], v11 offset:4096
  v_mfma_f32_32x32x16_bf16 v[160:175], v[32:35], v[44:47], v[160:175]
  ds_read_b64_tr_b16 v[60:61], v12 offset:6144
  ds_read_b64_tr_b16 v[62:63], v12 offset:6656
  v_mfma_f32_32x32x16_bf16 v[192:207], v[32:35], v[48:51], v[192:207]
  ds_read_b64_tr_b16 v[64:65], v12 offset:14336
  ds_read_b64_tr_b16 v[66:67], v12 offset:14848
  v_mfma_f32_32x32x16_bf16 v[144:159], v[40:43], v[36:39], v[144:159]
  ds_read_b64_tr_b16 v[68:69], v12 offset:22528
  ds_read_b64_tr_b16 v[70:71], v12 offset:23040
  v_mfma_f32_32x32x16_bf16 v[176:191], v[36:39], v[44:47], v[176:191]
  v_mfma_f32_32x32x16_bf16 v[208:223], v[36:39], v[48:51], v[208:223]
  s_add_u32 s64, s64, 1
  s_cmp_eq_u32 s64, 4
  s_cselect_b32 s65, 0xfffe2000, s62
  s_cselect_b32 s64, 0, s64
  s_add_u32 s63, s63, 1
  s_cmp_eq_u32 s63, 16
  s_waitcnt lgkmcnt(0)
  s_cbranch_scc1 L_g1last
  v_add_u32 v8, s65, v8
  v_add_u32 v9, s65, v9
  v_add_u32 v10, s65, v10
  v_add_u32 v11, s65, v11
  v_add_u32 v12, s65, v12
  s_barrier
  s_cmp_eq_u32 s63, 1
  s_cbranch_scc1 L_g1st
L_g1stb:
  v_mfma_f32_32x32x16_bf16 v[128:143], v[60:63], v[52:55], v[128:143]
  ds_read_b128 v[32:35], v8 offset:0
  ds_read_b128 v[36:39], v8 offset:4096
  v_mfma_f32_32x32x16_bf16 v[160:175], v[52:55], v[64:67], v[160:175]
  ds_read_b64_tr_b16 v[40:41], v12 offset:0
  ds_read_b64_tr_b16 v[42:43], v12 offset:512
  v_mfma_f32_32x32x16_bf16 v[192:207], v[52:55], v[68:71], v[192:207]
  ds_read_b64_tr_b16 v[44:45], v12 offset:8192
  ds_read_b64_tr_b16 v[46:47], v12 offset:8704
  v_mfma_f32_32x32x16_bf16 v[144:159], v[60:63], v[56:59], v[144:159]
  ds_read_b64_tr_b16 v[48:49], v12 offset:16384
  ds_read_b64_tr_b16 v[50:51], v12 offset:16896
  v_mfma_f32_32x32x16_bf16 v[176:191], v[56:59], v[64:67], v[176:191]
  v_mfma_f32_32x32x16_bf16 v[208:223], v[56:59], v[68:71], v[208:223]
  s_waitcnt lgkmcnt(0)
  v_mfma_f32_32x32x16_bf16 v[128:143], v[40:43], v[32:35], v[128:143]
  ds_read_b128 v[52:55], v9 offset:0
  ds_read_b128 v[56:59], v9 offset:4096
  v_mfma_f32_32x32x16_bf16 v[160:175], v[32:35], v[44:47], v[160:175]
  ds_read_b64_tr_b16 v[60:61], v12 offset:2048
  ds_read_b64_tr_b16 v[62:63], v12 offset:2560
  v_mfma_f32_32x32x16_bf16 v[192:207], v[32:35], v[48:51], v[192:207]
  ds_read_b64_tr_b16 v[64:65], v12 offset:10240
  ds_read_b64_tr_b16 v[66:67], v12 offset:10752
  v_mfma_f32_32x32x16_bf16 v[144:159], v[40:43], v[36:39], v[144:159]
  ds_read_b64_tr_b16 v[68:69], v12 offset:18432
  ds_read_b64_tr_b16 v[70:71], v12 offset:18944
  v_mfma_f32_32x32x16_bf16 v[176:191], v[36:39], v[44:47], v[176:191]
  v_mfma_f32_32x32x16_bf16 v[208:223], v[36:39], v[48:51], v[208:223]
  s_branch L_g1loop
L_g1st:
  s_lshl_b32 s60, s48, 14
  s_lshl_b32 s61, s51, 9
  s_add_u32 s60, s60, s61
  s_add_u32 s60, s60, s55
  v_lshlrev_b32 v5, 13, v3
  v_lshl_add_u32 v5, v2, 3, v5
  buffer_load_dwordx2 v[72:73], v5, s[8:11], s60 offen offset:0 sc1
  buffer_load_dwordx2 v[88:89], v5, s[8:11], s60 offen offset:256 sc1
  s_add_u32 s60, s60, 1024
  buffer_load_dwordx2 v[74:75], v5, s[8:11], s60 offen offset:0 sc1
  buffer_load_dwordx2 v[90:91], v5, s[8:11], s60 offen offset:256 sc1
  s_add_u32 s60, s60, 1024
  buffer_load_dwordx2 v[76:77], v5, s[8:11], s60 offen offset:0 sc1
  buffer_load_dwordx2 v[92:93], v5, s[8:11], s60 offen offset:256 sc1
  s_add_u32 s60, s60, 1024
  buffer_load_dwordx2 v[78:79], v5, s[8:11], s60 offen offset:0 sc1
  buffer_load_dwordx2 v[94:95], v5, s[8:11], s60 offen offset:256 sc1
  s_add_u32 s60, s60, 1024
  buffer_load_dwordx2 v[80:81], v5, s[8:11], s60 offen offset:0 sc1
  buffer_load_dwordx2 v[96:97], v5, s[8:11], s60 offen offset:256 sc1
  s_add_u32 s60, s60, 1024
  buffer_load_dwordx2 v[82:83], v5, s[8:11], s60 offen offset:0 sc1
  buffer_load_dwordx2 v[98:99], v5, s[8:11], s60 offen offset:256 sc1
  s_add_u32 s60, s60, 1024
  buffer_load_dwordx2 v[84:85], v5, s[8:11], s60 offen offset:0 sc1
  buffer_load_dwordx2 v[100:101], v5, s[8:11], s60 offen offset:256 sc1
  s_add_u32 s60, s60, 1024
  buffer_load_dwordx2 v[86:87], v5, s[8:11], s60 offen offset:0 sc1
  buffer_load_dwordx2 v[102:103], v5, s[8:11], s60 offen offset:256 sc1
  s_branch L_g1stb
L_g1last:
  v_mfma_f32_32x32x16_bf16 v[128:143], v[60:63], v[52:55], v[128:143]
  v_mfma_f32_32x32x16_bf16 v[160:175], v[52:55], v[64:67], v[160:175]
  v_mfma_f32_32x32x16_bf16 v[192:207], v[52:55], v[68:71], v[192:207]
  v_mfma_f32_32x32x16_bf16 v[144:159], v[60:63], v[56:59], v[144:159]
  v_mfma_f32_32x32x16_bf16 v[176:191], v[56:59], v[64:67], v[176:191]
  v_mfma_f32_32x32x16_bf16 v[208:223], v[56:59], v[68:71], v[208:223]
  s_waitcnt vmcnt(0)
  v_pk_add_f32 v[72:73], v[72:73], v[74:75]
  v_pk_add_f32 v[88:89], v[88:89], v[90:91]
  v_pk_add_f32 v[72:73], v[72:73], v[76:77]
  v_pk_add_f32 v[88:89], v[88:89], v[92:93]
  v_pk_add_f32 v[72:73], v[72:73], v[78:79]
  v_pk_add_f32 v[88:89], v[88:89], v[94:95]
  v_pk_add_f32 v[72:73], v[72:73], v[80:81]
  v_pk_add_f32 v[88:89], v[88:89], v[96:97]
  v_pk_add_f32 v[72:73], v[72:73], v[82:83]
  v_pk_add_f32 v[88:89], v[88:89], v[98:99]
  v_pk_add_f32 v[72:73], v[72:73], v[84:85]
  v_pk_add_f32 v[88:89], v[88:89], v[100:101]
  v_pk_add_f32 v[72:73], v[72:73], v[86:87]
  v_pk_add_f32 v[88:89], v[88:89], v[102:103]
  v_mov_b32 v74, v72
  v_mov_b32 v75, v73
  v_mov_b32 v90, v88
  v_mov_b32 v91, v89
  s_mov_b32 s60, 0x3a800000
  s_mov_b32 s61, 0x3727c5ac
  v_permlane32_swap_b32 v74, v72
  v_permlane32_swap_b32 v75, v73
  v_permlane32_swap_b32 v90, v88
  v_permlane32_swap_b32 v91, v89
  s_nop 0
  v_pk_add_f32 v[72:73], v[72:73], v[74:75]
  v_pk_add_f32 v[88:89], v[88:89], v[90:91]
  v_mul_f32 v16, s60, v72
  v_mul_f32 v73, s60, v73
  v_mul_f32 v18, s60, v88
  v_mul_f32 v89, s60, v89
  v_fma_f32 v73, -v16, v16, v73
  v_max_f32 v73, 0, v73
  v_add_f32 v73, s61, v73
  v_rsq_f32 v20, v73
  v_fma_f32 v89, -v18, v18, v89
  v_max_f32 v89, 0, v89
  v_add_f32 v89, s61, v89
  v_rsq_f32 v22, v89
  s_nop 0
  v_cmp_eq_u32 vcc, 1, v3
  s_lshl_b32 s60, s50, 8
  s_add_u32 s60, s60, 139264
  v_cndmask_b32 v32, v20, v22, vcc
  v_lshlrev_b32 v33, 2, v1
  v_add_u32 v33, s60, v33
  ds_write_b32 v33, v32
  v_lshlrev_b32 v33, 4, v3
  v_add_u32 v33, s60, v33
  ds_read_b128 v[64:67], v33 offset:0
  ds_read_b128 v[68:71], v33 offset:32
  ds_read_b128 v[72:75], v33 offset:64
  ds_read_b128 v[76:79], v33 offset:96
  ds_read_b128 v[80:83], v33 offset:128
  ds_read_b128 v[84:87], v33 offset:160
  ds_read_b128 v[88:91], v33 offset:192
  ds_read_b128 v[92:95], v33 offset:224
  v_cmp_eq_u32 vcc, 0, v3
  v_and_b32 v32, 0xffff0000, v16
  v_sub_f32 v33, v16, v32
  v_lshrrev_b32 v34, 16, v32
  v_or_b32 v40, v34, v32
  v_cvt_pk_bf16_f32 v41, v33, v33
  v_and_b32 v41, 0xffff, v41
  v_cndmask_b32 v40, 0, v40, vcc
  v_cndmask_b32 v41, 0, v41, vcc
  v_mov_b32 v42, 0
  v_mov_b32 v43, 0
  v_and_b32 v32, 0xffff0000, v18
  v_sub_f32 v33, v18, v32
  v_lshrrev_b32 v34, 16, v32
  v_or_b32 v44, v34, v32
  v_cvt_pk_bf16_f32 v45, v33, v33
  v_and_b32 v45, 0xffff, v45
  v_cndmask_b32 v44, 0, v44, vcc
  v_cndmask_b32 v45, 0, v45, vcc
  v_mov_b32 v46, 0
  v_mov_b32 v47, 0
  v_sub_f32 v35, 0, v19
  v_and_b32 v32, 0xffff0000, v35
  v_sub_f32 v33, v35, v32
  v_cvt_pk_bf16_f32 v52, v32, v33
  v_lshrrev_b32 v53, 16, v32
  v_cndmask_b32 v52, 0, v52, vcc
  v_cndmask_b32 v53, 0, v53, vcc
  v_mov_b32 v54, 0
  v_mov_b32 v55, 0
  v_sub_f32 v35, 0, v21
  v_and_b32 v32, 0xffff0000, v35
  v_sub_f32 v33, v35, v32
  v_cvt_pk_bf16_f32 v56, v32, v33
  v_lshrrev_b32 v57, 16, v32
  v_cndmask_b32 v56, 0, v56, vcc
  v_cndmask_b32 v57, 0, v57, vcc
  v_mov_b32 v58, 0
  v_mov_b32 v59, 0
  v_sub_f32 v35, 0, v17
  v_and_b32 v32, 0xffff0000, v35
  v_sub_f32 v33, v35, v32
  v_cvt_pk_bf16_f32 v48, v32, v33
  v_lshrrev_b32 v49, 16, v32
  v_cndmask_b32 v48, 0, v48, vcc
  v_cndmask_b32 v49, 0, v49, vcc
  v_mov_b32 v50, 0
  v_mov_b32 v51, 0
  s_mov_b32 s66, 0x3fb8aa3b
  s_mov_b32 s67, 0x3fb8aa3b
  v_mfma_f32_32x32x16_bf16 v[160:175], v[40:43], v[52:55], v[160:175]
  v_mfma_f32_32x32x16_bf16 v[176:191], v[44:47], v[52:55], v[176:191]
  v_mfma_f32_32x32x16_bf16 v[192:207], v[40:43], v[56:59], v[192:207]
  v_mfma_f32_32x32x16_bf16 v[208:223], v[44:47], v[56:59], v[208:223]
  v_mfma_f32_32x32x16_bf16 v[128:143], v[48:51], v[40:43], v[128:143]
  v_mfma_f32_32x32x16_bf16 v[144:159], v[48:51], v[44:47], v[144:159]
  s_mov_b32 s68, 0x358637bd
  s_mov_b32 s69, 0x358637bd
  s_waitcnt lgkmcnt(0)
  s_nop 4
  v_pk_mul_f32 v[160:161], v[160:161], v[64:65]
  v_pk_mul_f32 v[162:163], v[162:163], v[66:67]
  v_pk_mul_f32 v[164:165], v[164:165], v[68:69]
  v_pk_mul_f32 v[166:167], v[166:167], v[70:71]
  v_pk_mul_f32 v[168:169], v[168:169], v[72:73]
  v_pk_mul_f32 v[170:171], v[170:171], v[74:75]
  v_pk_mul_f32 v[172:173], v[172:173], v[76:77]
  v_pk_mul_f32 v[174:175], v[174:175], v[78:79]
  v_pk_mul_f32 v[176:177], v[176:177], v[80:81]
  v_pk_mul_f32 v[178:179], v[178:179], v[82:83]
  v_pk_mul_f32 v[180:181], v[180:181], v[84:85]
  v_pk_mul_f32 v[182:183], v[182:183], v[86:87]
  v_pk_mul_f32 v[184:185], v[184:185], v[88:89]
  v_pk_mul_f32 v[186:187], v[186:187], v[90:91]
  v_pk_mul_f32 v[188:189], v[188:189], v[92:93]
  v_pk_mul_f32 v[190:191], v[190:191], v[94:95]
  v_pk_mul_f32 v[32:33], v[160:161], s[66:67]
  v_pk_mul_f32 v[34:35], v[162:163], s[66:67]
  v_pk_mul_f32 v[36:37], v[164:165], s[66:67]
  v_pk_mul_f32 v[38:39], v[166:167], s[66:67]
  v_exp_f32 v32, v32 clamp
  v_exp_f32 v33, v33 clamp
  v_exp_f32 v34, v34 clamp
  v_exp_f32 v35, v35 clamp
  v_exp_f32 v36, v36 clamp
  v_exp_f32 v37, v37 clamp
  v_exp_f32 v38, v38 clamp
  v_exp_f32 v39, v39 clamp
  v_max_f32 v160, 0, v160
  v_max_f32 v161, 0, v161
  v_max_f32 v162, 0, v162
  v_max_f32 v163, 0, v163
  v_max_f32 v164, 0, v164
  v_max_f32 v165, 0, v165
  v_max_f32 v166, 0, v166
  v_max_f32 v167, 0, v167
  v_pk_add_f32 v[32:33], v[32:33], s[68:69]
  v_pk_add_f32 v[34:35], v[34:35], s[68:69]
  v_pk_add_f32 v[36:37], v[36:37], s[68:69]
  v_pk_add_f32 v[38:39], v[38:39], s[68:69]
  v_pk_add_f32 v[160:161], v[160:161], v[32:33]
  v_pk_add_f32 v[162:163], v[162:163], v[34:35]
  v_pk_add_f32 v[164:165], v[164:165], v[36:37]
  v_pk_add_f32 v[166:167], v[166:167], v[38:39]
  v_pk_mul_f32 v[32:33], v[168:169], s[66:67]
  v_pk_mul_f32 v[34:35], v[170:171], s[66:67]
  v_pk_mul_f32 v[36:37], v[172:173], s[66:67]
  v_pk_mul_f32 v[38:39], v[174:175], s[66:67]
  v_exp_f32 v32, v32 clamp
  v_exp_f32 v33, v33 clamp
  v_exp_f32 v34, v34 clamp
  v_exp_f32 v35, v35 clamp
  v_exp_f32 v36, v36 clamp
  v_exp_f32 v37, v37 clamp
  v_exp_f32 v38, v38 clamp
  v_exp_f32 v39, v39 clamp
  v_max_f32 v168, 0, v168
  v_max_f32 v169, 0, v169
  v_max_f32 v170, 0, v170
  v_max_f32 v171, 0, v171
  v_max_f32 v172, 0, v172
  v_max_f32 v173, 0, v173
  v_max_f32 v174, 0, v174
  v_max_f32 v175, 0, v175
  v_pk_add_f32 v[32:33], v[32:33], s[68:69]
  v_pk_add_f32 v[34:35], v[34:35], s[68:69]
  v_pk_add_f32 v[36:37], v[36:37], s[68:69]
  v_pk_add_f32 v[38:39], v[38:39], s[68:69]
  v_pk_add_f32 v[168:169], v[168:169], v[32:33]
  v_pk_add_f32 v[170:171], v[170:171], v[34:35]
  v_pk_add_f32 v[172:173], v[172:173], v[36:37]
  v_pk_add_f32 v[174:175], v[174:175], v[38:39]
  v_pk_mul_f32 v[32:33], v[176:177], s[66:67]
  v_pk_mul_f32 v[34:35], v[178:179], s[66:67]
  v_pk_mul_f32 v[36:37], v[180:181], s[66:67]
  v_pk_mul_f32 v[38:39], v[182:183], s[66:67]
  v_exp_f32 v32, v32 clamp
  v_exp_f32 v33, v33 clamp
  v_exp_f32 v34, v34 clamp
  v_exp_f32 v35, v35 clamp
  v_exp_f32 v36, v36 clamp
  v_exp_f32 v37, v37 clamp
  v_exp_f32 v38, v38 clamp
  v_exp_f32 v39, v39 clamp
  v_max_f32 v176, 0, v176
  v_max_f32 v177, 0, v177
  v_max_f32 v178, 0, v178
  v_max_f32 v179, 0, v179
  v_max_f32 v180, 0, v180
  v_max_f32 v181, 0, v181
  v_max_f32 v182, 0, v182
  v_max_f32 v183, 0, v183
  v_pk_add_f32 v[32:33], v[32:33], s[68:69]
  v_pk_add_f32 v[34:35], v[34:35], s[68:69]
  v_pk_add_f32 v[36:37], v[36:37], s[68:69]
  v_pk_add_f32 v[38:39], v[38:39], s[68:69]
  v_pk_add_f32 v[176:177], v[176:177], v[32:33]
  v_pk_add_f32 v[178:179], v[178:179], v[34:35]
  v_pk_add_f32 v[180:181], v[180:181], v[36:37]
  v_pk_add_f32 v[182:183], v[182:183], v[38:39]
  v_pk_mul_f32 v[32:33], v[184:185], s[66:67]
  v_pk_mul_f32 v[34:35], v[186:187], s[66:67]
  v_pk_mul_f32 v[36:37], v[188:189], s[66:67]
  v_pk_mul_f32 v[38:39], v[190:191], s[66:67]
  v_exp_f32 v32, v32 clamp
  v_exp_f32 v33, v33 clamp
  v_exp_f32 v34, v34 clamp
  v_exp_f32 v35, v35 clamp
  v_exp_f32 v36, v36 clamp
  v_exp_f32 v37, v37 clamp
  v_exp_f32 v38, v38 clamp
  v_exp_f32 v39, v39 clamp
  v_max_f32 v184, 0, v184
  v_max_f32 v185, 0, v185
  v_max_f32 v186, 0, v186
  v_max_f32 v187, 0, v187
  v_max_f32 v188, 0, v188
  v_max_f32 v189, 0, v189
  v_max_f32 v190, 0, v190
  v_max_f32 v191, 0, v191
  v_pk_add_f32 v[32:33], v[32:33], s[68:69]
  v_pk_add_f32 v[34:35], v[34:35], s[68:69]
  v_pk_add_f32 v[36:37], v[36:37], s[68:69]
  v_pk_add_f32 v[38:39], v[38:39], s[68:69]
  v_pk_add_f32 v[184:185], v[184:185], v[32:33]
  v_pk_add_f32 v[186:187], v[186:187], v[34:35]
  v_pk_add_f32 v[188:189], v[188:189], v[36:37]
  v_pk_add_f32 v[190:191], v[190:191], v[38:39]
  v_pk_mul_f32 v[192:193], v[192:193], v[64:65]
  v_pk_mul_f32 v[194:195], v[194:195], v[66:67]
  v_pk_mul_f32 v[196:197], v[196:197], v[68:69]
  v_pk_mul_f32 v[198:199], v[198:199], v[70:71]
  v_pk_mul_f32 v[200:201], v[200:201], v[72:73]
  v_pk_mul_f32 v[202:203], v[202:203], v[74:75]
  v_pk_mul_f32 v[204:205], v[204:205], v[76:77]
  v_pk_mul_f32 v[206:207], v[206:207], v[78:79]
  v_pk_mul_f32 v[208:209], v[208:209], v[80:81]
  v_pk_mul_f32 v[210:211], v[210:211], v[82:83]
  v_pk_mul_f32 v[212:213], v[212:213], v[84:85]
  v_pk_mul_f32 v[214:215], v[214:215], v[86:87]
  v_pk_mul_f32 v[216:217], v[216:217], v[88:89]
  v_pk_mul_f32 v[218:219], v[218:219], v[90:91]
  v_pk_mul_f32 v[220:221], v[220:221], v[92:93]
  v_pk_mul_f32 v[222:223], v[222:223], v[94:95]
  v_cvt_pk_bf16_f32 v96, v160, v161
  v_cvt_pk_bf16_f32 v112, v192, v193
  v_cvt_pk_bf16_f32 v97, v162, v163
  v_cvt_pk_bf16_f32 v113, v194, v195
  v_cvt_pk_bf16_f32 v98, v164, v165
  v_cvt_pk_bf16_f32 v114, v196, v197
  v_cvt_pk_bf16_f32 v99, v166, v167
  v_cvt_pk_bf16_f32 v115, v198, v199
  v_cvt_pk_bf16_f32 v100, v168, v169
  v_cvt_pk_bf16_f32 v116, v200, v201
  v_cvt_pk_bf16_f32 v101, v170, v171
  v_cvt_pk_bf16_f32 v117, v202, v203
  v_cvt_pk_bf16_f32 v102, v172, v173
  v_cvt_pk_bf16_f32 v118, v204, v205
  v_cvt_pk_bf16_f32 v103, v174, v175
  v_cvt_pk_bf16_f32 v119, v206, v207
  v_cvt_pk_bf16_f32 v104, v176, v177
  v_cvt_pk_bf16_f32 v120, v208, v209
  v_cvt_pk_bf16_f32 v105, v178, v179
  v_cvt_pk_bf16_f32 v121, v210, v211
  v_cvt_pk_bf16_f32 v106, v180, v181
  v_cvt_pk_bf16_f32 v122, v212, v213
  v_cvt_pk_bf16_f32 v107, v182, v183
  v_cvt_pk_bf16_f32 v123, v214, v215
  v_cvt_pk_bf16_f32 v108, v184, v185
  v_cvt_pk_bf16_f32 v124, v216, v217
  v_cvt_pk_bf16_f32 v109, v186, v187
  v_cvt_pk_bf16_f32 v125, v218, v219
  v_cvt_pk_bf16_f32 v110, v188, v189
  v_cvt_pk_bf16_f32 v126, v220, v221
  v_cvt_pk_bf16_f32 v111, v190, v191
  v_cvt_pk_bf16_f32 v127, v222, v223
  v_mfma_f32_32x32x16_bf16 v[64:79], v[96:99], v[112:115], 0
  v_mfma_f32_32x32x16_bf16 v[64:79], v[100:103], v[116:119], v[64:79]
  v_mfma_f32_32x32x16_bf16 v[64:79], v[104:107], v[120:123], v[64:79]
  v_mfma_f32_32x32x16_bf16 v[64:79], v[108:111], v[124:127], v[64:79]
  v_pk_add_f32 v[42:43], v[160:161], v[162:163]
  v_pk_add_f32 v[42:43], v[42:43], v[164:165]
  v_pk_add_f32 v[42:43], v[42:43], v[166:167]
  v_pk_add_f32 v[42:43], v[42:43], v[168:169]
  v_pk_add_f32 v[42:43], v[42:43], v[170:171]
  v_pk_add_f32 v[42:43], v[42:43], v[172:173]
  v_pk_add_f32 v[42:43], v[42:43], v[174:175]
  v_pk_add_f32 v[42:43], v[42:43], v[176:177]
  v_pk_add_f32 v[42:43], v[42:43], v[178:179]
  v_pk_add_f32 v[42:43], v[42:43], v[180:181]
  v_pk_add_f32 v[42:43], v[42:43], v[182:183]
  v_pk_add_f32 v[42:43], v[42:43], v[184:185]
  v_pk_add_f32 v[42:43], v[42:43], v[186:187]
  v_pk_add_f32 v[42:43], v[42:43], v[188:189]
  v_pk_add_f32 v[42:43], v[42:43], v[190:191]
  v_add_f32 v42, v42, v43
  v_mov_b32 v43, v42
  s_mul_i32 s60, s52, 4352
  s_add_u32 s60, s60, 122880
  v_permlane32_swap_b32 v43, v42
  v_lshlrev_b32 v6, 4, v1
  v_add_u32 v8, s60, v6
  v_add_f32 v42, v42, v43
  v_lshlrev_b32 v9, 2, v1
  v_add_u32 v9, s60, v9
  s_cmp_eq_u32 s51, 0
  s_cbranch_scc1 L_kvw0
  s_nop 1
  ds_write_b128 v8, v[64:67] offset:0
  ds_write_b128 v8, v[68:71] offset:1024
  ds_write_b128 v8, v[72:75] offset:2048
  ds_write_b128 v8, v[76:79] offset:3072
  ds_write_b32 v9, v42 offset:4096
  s_waitcnt lgkmcnt(0)
  s_barrier
  s_branch L_kvw1
L_kvw0:
  s_lshl_b32 s60, s49, 1
  s_add_u32 s60, s60, s52
  s_lshl_b32 s60, s60, 4
  s_add_u32 s60, s60, s48
  s_mul_i32 s60, s60, 2304
  s_add_u32 s60, s60, s56
  v_lshlrev_b32 v7, 2, v1
  v_add_u32 v7, 2048, v7
  s_barrier
  ds_read_b128 v[44:47], v8 offset:0
  ds_read_b128 v[48:51], v8 offset:1024
  ds_read_b128 v[52:55], v8 offset:2048
  ds_read_b128 v[56:59], v8 offset:3072
  ds_read_b32 v60, v9 offset:4096
  s_waitcnt lgkmcnt(0)
  v_pk_add_f32 v[64:65], v[64:65], v[44:45]
  v_pk_add_f32 v[66:67], v[66:67], v[46:47]
  v_pk_add_f32 v[68:69], v[68:69], v[48:49]
  v_pk_add_f32 v[70:71], v[70:71], v[50:51]
  v_pk_add_f32 v[72:73], v[72:73], v[52:53]
  v_pk_add_f32 v[74:75], v[74:75], v[54:55]
  v_pk_add_f32 v[76:77], v[76:77], v[56:57]
  v_pk_add_f32 v[78:79], v[78:79], v[58:59]
  v_add_f32 v42, v42, v60
  v_cvt_pk_bf16_f32 v32, v64, v65
  v_cvt_pk_bf16_f32 v33, v66, v67
  v_cvt_pk_bf16_f32 v34, v68, v69
  v_cvt_pk_bf16_f32 v35, v70, v71
  v_cvt_pk_bf16_f32 v36, v72, v73
  v_cvt_pk_bf16_f32 v37, v74, v75
  v_cvt_pk_bf16_f32 v38, v76, v77
  v_cvt_pk_bf16_f32 v39, v78, v79
  buffer_store_dwordx4 v[32:35], v6, s[8:11], s60 offen offset:0 sc1
  buffer_store_dwordx4 v[36:39], v6, s[8:11], s60 offen offset:1024 sc1
  v_cmp_gt_u32 vcc, 32, v1
  s_and_saveexec_b64 s[90:91], vcc
  buffer_store_dword v42, v7, s[8:11], s60 offen sc1
  s_mov_b64 exec, s[90:91]
  s_waitcnt vmcnt(0)
L_kvw1:
  s_barrier
  v_pk_mul_f32 v[128:129], v[128:129], v[20:21] op_sel_hi:[1,0]
  v_pk_mul_f32 v[130:131], v[130:131], v[20:21] op_sel_hi:[1,0]
  v_pk_mul_f32 v[132:133], v[132:133], v[20:21] op_sel_hi:[1,0]
  v_pk_mul_f32 v[134:135], v[134:135], v[20:21] op_sel_hi:[1,0]
  v_pk_mul_f32 v[136:137], v[136:137], v[20:21] op_sel_hi:[1,0]
  v_pk_mul_f32 v[138:139], v[138:139], v[20:21] op_sel_hi:[1,0]
  v_pk_mul_f32 v[140:141], v[140:141], v[20:21] op_sel_hi:[1,0]
  v_pk_mul_f32 v[142:143], v[142:143], v[20:21] op_sel_hi:[1,0]
  v_pk_mul_f32 v[144:145], v[144:145], v[22:23] op_sel_hi:[1,0]
  v_pk_mul_f32 v[146:147], v[146:147], v[22:23] op_sel_hi:[1,0]
  v_pk_mul_f32 v[148:149], v[148:149], v[22:23] op_sel_hi:[1,0]
  v_pk_mul_f32 v[150:151], v[150:151], v[22:23] op_sel_hi:[1,0]
  v_pk_mul_f32 v[152:153], v[152:153], v[22:23] op_sel_hi:[1,0]
  v_pk_mul_f32 v[154:155], v[154:155], v[22:23] op_sel_hi:[1,0]
  v_pk_mul_f32 v[156:157], v[156:157], v[22:23] op_sel_hi:[1,0]
  v_pk_mul_f32 v[158:159], v[158:159], v[22:23] op_sel_hi:[1,0]
  v_pk_mul_f32 v[32:33], v[128:129], s[66:67]
  v_pk_mul_f32 v[34:35], v[130:131], s[66:67]
  v_pk_mul_f32 v[36:37], v[132:133], s[66:67]
  v_pk_mul_f32 v[38:39], v[134:135], s[66:67]
  v_exp_f32 v32, v32 clamp
  v_exp_f32 v33, v33 clamp
  v_exp_f32 v34, v34 clamp
  v_exp_f32 v35, v35 clamp
  v_exp_f32 v36, v36 clamp
  v_exp_f32 v37, v37 clamp
  v_exp_f32 v38, v38 clamp
  v_exp_f32 v39, v39 clamp
  v_max_f32 v128, 0, v128
  v_max_f32 v129, 0, v129
  v_max_f32 v130, 0, v130
  v_max_f32 v131, 0, v131
  v_max_f32 v132, 0, v132
  v_max_f32 v133, 0, v133
  v_max_f32 v134, 0, v134
  v_max_f32 v135, 0, v135
  v_pk_add_f32 v[32:33], v[32:33], s[68:69]
  v_pk_add_f32 v[34:35], v[34:35], s[68:69]
  v_pk_add_f32 v[36:37], v[36:37], s[68:69]
  v_pk_add_f32 v[38:39], v[38:39], s[68:69]
  v_pk_add_f32 v[128:129], v[128:129], v[32:33]
  v_pk_add_f32 v[130:131], v[130:131], v[34:35]
  v_pk_add_f32 v[132:133], v[132:133], v[36:37]
  v_pk_add_f32 v[134:135], v[134:135], v[38:39]
  v_pk_mul_f32 v[32:33], v[136:137], s[66:67]
  v_pk_mul_f32 v[34:35], v[138:139], s[66:67]
  v_pk_mul_f32 v[36:37], v[140:141], s[66:67]
  v_pk_mul_f32 v[38:39], v[142:143], s[66:67]
  v_exp_f32 v32, v32 clamp
  v_exp_f32 v33, v33 clamp
  v_exp_f32 v34, v34 clamp
  v_exp_f32 v35, v35 clamp
  v_exp_f32 v36, v36 clamp
  v_exp_f32 v37, v37 clamp
  v_exp_f32 v38, v38 clamp
  v_exp_f32 v39, v39 clamp
  v_max_f32 v136, 0, v136
  v_max_f32 v137, 0, v137
  v_max_f32 v138, 0, v138
  v_max_f32 v139, 0, v139
  v_max_f32 v140, 0, v140
  v_max_f32 v141, 0, v141
  v_max_f32 v142, 0, v142
  v_max_f32 v143, 0, v143
  v_pk_add_f32 v[32:33], v[32:33], s[68:69]
  v_pk_add_f32 v[34:35], v[34:35], s[68:69]
  v_pk_add_f32 v[36:37], v[36:37], s[68:69]
  v_pk_add_f32 v[38:39], v[38:39], s[68:69]
  v_pk_add_f32 v[136:137], v[136:137], v[32:33]
  v_pk_add_f32 v[138:139], v[138:139], v[34:35]
  v_pk_add_f32 v[140:141], v[140:141], v[36:37]
  v_pk_add_f32 v[142:143], v[142:143], v[38:39]
  v_pk_mul_f32 v[32:33], v[144:145], s[66:67]
  v_pk_mul_f32 v[34:35], v[146:147], s[66:67]
  v_pk_mul_f32 v[36:37], v[148:149], s[66:67]
  v_pk_mul_f32 v[38:39], v[150:151], s[66:67]
  v_exp_f32 v32, v32 clamp
  v_exp_f32 v33, v33 clamp
  v_exp_f32 v34, v34 clamp
  v_exp_f32 v35, v35 clamp
  v_exp_f32 v36, v36 clamp
  v_exp_f32 v37, v37 clamp
  v_exp_f32 v38, v38 clamp
  v_exp_f32 v39, v39 clamp
  v_max_f32 v144, 0, v144
  v_max_f32 v145, 0, v145
  v_max_f32 v146, 0, v146
  v_max_f32 v147, 0, v147
  v_max_f32 v148, 0, v148
  v_max_f32 v149, 0, v149
  v_max_f32 v150, 0, v150
  v_max_f32 v151, 0, v151
  v_pk_add_f32 v[32:33], v[32:33], s[68:69]
  v_pk_add_f32 v[34:35], v[34:35], s[68:69]
  v_pk_add_f32 v[36:37], v[36:37], s[68:69]
  v_pk_add_f32 v[38:39], v[38:39], s[68:69]
  v_pk_add_f32 v[144:145], v[144:145], v[32:33]
  v_pk_add_f32 v[146:147], v[146:147], v[34:35]
  v_pk_add_f32 v[148:149], v[148:149], v[36:37]
  v_pk_add_f32 v[150:151], v[150:151], v[38:39]
  v_pk_mul_f32 v[32:33], v[152:153], s[66:67]
  v_pk_mul_f32 v[34:35], v[154:155], s[66:67]
  v_pk_mul_f32 v[36:37], v[156:157], s[66:67]
  v_pk_mul_f32 v[38:39], v[158:159], s[66:67]
  v_exp_f32 v32, v32 clamp
  v_exp_f32 v33, v33 clamp
  v_exp_f32 v34, v34 clamp
  v_exp_f32 v35, v35 clamp
  v_exp_f32 v36, v36 clamp
  v_exp_f32 v37, v37 clamp
  v_exp_f32 v38, v38 clamp
  v_exp_f32 v39, v39 clamp
  v_max_f32 v152, 0, v152
  v_max_f32 v153, 0, v153
  v_max_f32 v154, 0, v154
  v_max_f32 v155, 0, v155
  v_max_f32 v156, 0, v156
  v_max_f32 v157, 0, v157
  v_max_f32 v158, 0, v158
  v_max_f32 v159, 0, v159
  v_pk_add_f32 v[32:33], v[32:33], s[68:69]
  v_pk_add_f32 v[34:35], v[34:35], s[68:69]
  v_pk_add_f32 v[36:37], v[36:37], s[68:69]
  v_pk_add_f32 v[38:39], v[38:39], s[68:69]
  v_pk_add_f32 v[152:153], v[152:153], v[32:33]
  v_pk_add_f32 v[154:155], v[154:155], v[34:35]
  v_pk_add_f32 v[156:157], v[156:157], v[36:37]
  v_pk_add_f32 v[158:159], v[158:159], v[38:39]
  v_cvt_pk_bf16_f32 v96, v128, v129
  v_cvt_pk_bf16_f32 v97, v130, v131
  v_cvt_pk_bf16_f32 v98, v132, v133
  v_cvt_pk_bf16_f32 v99, v134, v135
  v_cvt_pk_bf16_f32 v100, v136, v137
  v_cvt_pk_bf16_f32 v101, v138, v139
  v_cvt_pk_bf16_f32 v102, v140, v141
  v_cvt_pk_bf16_f32 v103, v142, v143
  v_cvt_pk_bf16_f32 v104, v144, v145
  v_cvt_pk_bf16_f32 v105, v146, v147
  v_cvt_pk_bf16_f32 v106, v148, v149
  v_cvt_pk_bf16_f32 v107, v150, v151
  v_cvt_pk_bf16_f32 v108, v152, v153
  v_cvt_pk_bf16_f32 v109, v154, v155
  v_cvt_pk_bf16_f32 v110, v156, v157
  v_cvt_pk_bf16_f32 v111, v158, v159
  v_add_u32 v8, 0, v27
  v_xor_b32 v9, 32, v8
  v_xor_b32 v10, 64, v8
  v_xor_b32 v11, 96, v8
  v_add_u32 v12, 16384, v28
  s_barrier
  s_lshl_b32 s60, s49, 1
  s_add_u32 s60, s60, s52
  s_lshl_b32 s60, s60, 4
  s_lshr_b32 s61, s50, 2
  s_lshl_b32 s61, s61, 1
  s_add_u32 s61, s61, s51
  s_lshl_b32 s61, s61, 2
  s_add_u32 s60, s60, s61
  s_mul_i32 s60, s60, 2304
  s_add_u32 s60, s60, s56
  v_lshlrev_b32 v6, 4, v1
  v_lshlrev_b32 v7, 2, v2
  v_add_u32 v7, 2048, v7
  buffer_load_dwordx4 v[128:131], v6, s[8:11], s60 offen offset:0 sc1
  buffer_load_dwordx4 v[132:135], v6, s[8:11], s60 offen offset:1024 sc1
  buffer_load_dword v48, v7, s[8:11], s60 offen sc1
  s_add_u32 s60, s60, 2304
  buffer_load_dwordx4 v[136:139], v6, s[8:11], s60 offen offset:0 sc1
  buffer_load_dwordx4 v[140:143], v6, s[8:11], s60 offen offset:1024 sc1
  buffer_load_dword v49, v7, s[8:11], s60 offen sc1
  s_add_u32 s60, s60, 2304
  buffer_load_dwordx4 v[144:147], v6, s[8:11], s60 offen offset:0 sc1
  buffer_load_dwordx4 v[148:151], v6, s[8:11], s60 offen offset:1024 sc1
  buffer_load_dword v50, v7, s[8:11], s60 offen sc1
  s_add_u32 s60, s60, 2304
  buffer_load_dwordx4 v[152:155], v6, s[8:11], s60 offen offset:0 sc1
  buffer_load_dwordx4 v[156:159], v6, s[8:11], s60 offen offset:1024 sc1
  buffer_load_dword v51, v7, s[8:11], s60 offen sc1
  s_lshr_b32 s63, s50, 1
  s_add_u32 s63, s63, 1
  s_mul_i32 s63, s63, 24576
  s_lshl_b32 s64, s51, 13
  s_add_u32 s63, s63, s64
  v_add_u32 v13, s63, v6
  v_lshlrev_b32 v14, 2, v1
  v_add_u32 v14, s63, v14
  s_waitcnt vmcnt(9)
  v_lshlrev_b32 v32, 16, v128
  v_and_b32 v33, 0xffff0000, v128
  v_lshlrev_b32 v34, 16, v129
  v_and_b32 v35, 0xffff0000, v129
  v_lshlrev_b32 v36, 16, v130
  v_and_b32 v37, 0xffff0000, v130
  v_lshlrev_b32 v38, 16, v131
  v_and_b32 v39, 0xffff0000, v131
  v_lshlrev_b32 v40, 16, v132
  v_and_b32 v41, 0xffff0000, v132
  v_lshlrev_b32 v42, 16, v133
  v_and_b32 v43, 0xffff0000, v133
  v_lshlrev_b32 v44, 16, v134
  v_and_b32 v45, 0xffff0000, v134
  v_lshlrev_b32 v46, 16, v135
  v_and_b32 v47, 0xffff0000, v135
  s_waitcnt vmcnt(6)
  v_lshlrev_b32 v52, 16, v136
  v_and_b32 v53, 0xffff0000, v136
  v_pk_add_f32 v[32:33], v[32:33], v[52:53]
  v_lshlrev_b32 v54, 16, v137
  v_and_b32 v55, 0xffff0000, v137
  v_pk_add_f32 v[34:35], v[34:35], v[54:55]
  v_lshlrev_b32 v52, 16, v138
  v_and_b32 v53, 0xffff0000, v138
  v_pk_add_f32 v[36:37], v[36:37], v[52:53]
  v_lshlrev_b32 v54, 16, v139
  v_and_b32 v55, 0xffff0000, v139
  v_pk_add_f32 v[38:39], v[38:39], v[54:55]
  v_lshlrev_b32 v52, 16, v140
  v_and_b32 v53, 0xffff0000, v140
  v_pk_add_f32 v[40:41], v[40:41], v[52:53]
  v_lshlrev_b32 v54, 16, v141
  v_and_b32 v55, 0xffff0000, v141
  v_pk_add_f32 v[42:43], v[42:43], v[54:55]
  v_lshlrev_b32 v52, 16, v142
  v_and_b32 v53, 0xffff0000, v142
  v_pk_add_f32 v[44:45], v[44:45], v[52:53]
  v_lshlrev_b32 v54, 16, v143
  v_and_b32 v55, 0xffff0000, v143
  v_pk_add_f32 v[46:47], v[46:47], v[54:55]
  s_waitcnt vmcnt(3)
  v_lshlrev_b32 v52, 16, v144
  v_and_b32 v53, 0xffff0000, v144
  v_pk_add_f32 v[32:33], v[32:33], v[52:53]
  v_lshlrev_b32 v54, 16, v145
  v_and_b32 v55, 0xffff0000, v145
  v_pk_add_f32 v[34:35], v[34:35], v[54:55]
  v_lshlrev_b32 v52, 16, v146
  v_and_b32 v53, 0xffff0000, v146
  v_pk_add_f32 v[36:37], v[36:37], v[52:53]
  v_lshlrev_b32 v54, 16, v147
  v_and_b32 v55, 0xffff0000, v147
  v_pk_add_f32 v[38:39], v[38:39], v[54:55]
  v_lshlrev_b32 v52, 16, v148
  v_and_b32 v53, 0xffff0000, v148
  v_pk_add_f32 v[40:41], v[40:41], v[52:53]
  v_lshlrev_b32 v54, 16, v149
  v_and_b32 v55, 0xffff0000, v149
  v_pk_add_f32 v[42:43], v[42:43], v[54:55]
  v_lshlrev_b32 v52, 16, v150
  v_and_b32 v53, 0xffff0000, v150
  v_pk_add_f32 v[44:45], v[44:45], v[52:53]
  v_lshlrev_b32 v54, 16, v151
  v_and_b32 v55, 0xffff0000, v151
  v_pk_add_f32 v[46:47], v[46:47], v[54:55]
  s_waitcnt vmcnt(0)
  v_lshlrev_b32 v52, 16, v152
  v_and_b32 v53, 0xffff0000, v152
  v_pk_add_f32 v[32:33], v[32:33], v[52:53]
  v_lshlrev_b32 v54, 16, v153
  v_and_b32 v55, 0xffff0000, v153
  v_pk_add_f32 v[34:35], v[34:35], v[54:55]
  v_lshlrev_b32 v52, 16, v154
  v_and_b32 v53, 0xffff0000, v154
  v_pk_add_f32 v[36:37], v[36:37], v[52:53]
  v_lshlrev_b32 v54, 16, v155
  v_and_b32 v55, 0xffff0000, v155
  v_pk_add_f32 v[38:39], v[38:39], v[54:55]
  v_lshlrev_b32 v52, 16, v156
  v_and_b32 v53, 0xffff0000, v156
  v_pk_add_f32 v[40:41], v[40:41], v[52:53]
  v_lshlrev_b32 v54, 16, v157
  v_and_b32 v55, 0xffff0000, v157
  v_pk_add_f32 v[42:43], v[42:43], v[54:55]
  v_lshlrev_b32 v52, 16, v158
  v_and_b32 v53, 0xffff0000, v158
  v_pk_add_f32 v[44:45], v[44:45], v[52:53]
  v_lshlrev_b32 v54, 16, v159
  v_and_b32 v55, 0xffff0000, v159
  v_pk_add_f32 v[46:47], v[46:47], v[54:55]
  v_add_f32 v48, v48, v49
  v_add_f32 v48, v48, v50
  v_add_f32 v48, v48, v51
  ds_write_b128 v13, v[32:35] offset:0
  ds_write_b128 v13, v[36:39] offset:1024
  ds_write_b128 v13, v[40:43] offset:2048
  ds_write_b128 v13, v[44:47] offset:3072
  ds_write_b32 v14, v48 offset:4096
  s_waitcnt lgkmcnt(0)
  s_barrier
  s_mul_i32 s60, s52, 24576
  s_add_u32 s60, s60, 24576
  v_add_u32 v13, s60, v6
  v_lshlrev_b32 v14, 4, v3
  v_add_u32 v14, s60, v14
  ds_read_b128 v[128:131], v13 offset:0
  ds_read_b128 v[132:135], v13 offset:1024
  ds_read_b128 v[136:139], v13 offset:2048
  ds_read_b128 v[140:143], v13 offset:3072
  ds_read_b128 v[144:147], v13 offset:8192
  ds_read_b128 v[148:151], v13 offset:9216
  ds_read_b128 v[152:155], v13 offset:10240
  ds_read_b128 v[156:159], v13 offset:11264
  s_waitcnt lgkmcnt(0)
  ds_read_b128 v[160:163], v13 offset:49152
  ds_read_b128 v[164:167], v13 offset:50176
  ds_read_b128 v[168:171], v13 offset:51200
  ds_read_b128 v[172:175], v13 offset:52224
  ds_read_b128 v[176:179], v13 offset:57344
  ds_read_b128 v[180:183], v13 offset:58368
  ds_read_b128 v[184:187], v13 offset:59392
  ds_read_b128 v[188:191], v13 offset:60416
  s_waitcnt lgkmcnt(0)
  ds_read_b128 v[32:35], v14 offset:4096
  ds_read_b128 v[36:39], v14 offset:4128
  ds_read_b128 v[40:43], v14 offset:4160
  ds_read_b128 v[44:47], v14 offset:4192
  ds_read_b128 v[48:51], v14 offset:12288
  ds_read_b128 v[52:55], v14 offset:12320
  ds_read_b128 v[56:59], v14 offset:12352
  ds_read_b128 v[60:63], v14 offset:12384
  s_waitcnt lgkmcnt(0)
  ds_read_b128 v[64:67], v14 offset:53248
  ds_read_b128 v[68:71], v14 offset:53280
  ds_read_b128 v[72:75], v14 offset:53312
  ds_read_b128 v[76:79], v14 offset:53344
  ds_read_b128 v[80:83], v14 offset:61440
  ds_read_b128 v[84:87], v14 offset:61472
  ds_read_b128 v[88:91], v14 offset:61504
  ds_read_b128 v[92:95], v14 offset:61536
  v_pk_add_f32 v[128:129], v[128:129], v[144:145]
  v_pk_add_f32 v[160:161], v[160:161], v[176:177]
  v_pk_add_f32 v[130:131], v[130:131], v[146:147]
  v_pk_add_f32 v[162:163], v[162:163], v[178:179]
  v_pk_add_f32 v[132:133], v[132:133], v[148:149]
  v_pk_add_f32 v[164:165], v[164:165], v[180:181]
  v_pk_add_f32 v[134:135], v[134:135], v[150:151]
  v_pk_add_f32 v[166:167], v[166:167], v[182:183]
  v_pk_add_f32 v[136:137], v[136:137], v[152:153]
  v_pk_add_f32 v[168:169], v[168:169], v[184:185]
  v_pk_add_f32 v[138:139], v[138:139], v[154:155]
  v_pk_add_f32 v[170:171], v[170:171], v[186:187]
  v_pk_add_f32 v[140:141], v[140:141], v[156:157]
  v_pk_add_f32 v[172:173], v[172:173], v[188:189]
  v_pk_add_f32 v[142:143], v[142:143], v[158:159]
  v_pk_add_f32 v[174:175], v[174:175], v[190:191]
  v_pk_add_f32 v[128:129], v[128:129], v[160:161]
  v_pk_add_f32 v[130:131], v[130:131], v[162:163]
  v_pk_add_f32 v[132:133], v[132:133], v[164:165]
  v_pk_add_f32 v[134:135], v[134:135], v[166:167]
  v_pk_add_f32 v[136:137], v[136:137], v[168:169]
  v_pk_add_f32 v[138:139], v[138:139], v[170:171]
  v_pk_add_f32 v[140:141], v[140:141], v[172:173]
  v_pk_add_f32 v[142:143], v[142:143], v[174:175]
  v_cvt_pk_bf16_f32 v176, v128, v129
  v_cvt_pk_bf16_f32 v177, v130, v131
  v_cvt_pk_bf16_f32 v178, v132, v133
  v_cvt_pk_bf16_f32 v179, v134, v135
  v_cvt_pk_bf16_f32 v180, v136, v137
  v_cvt_pk_bf16_f32 v181, v138, v139
  v_cvt_pk_bf16_f32 v182, v140, v141
  v_cvt_pk_bf16_f32 v183, v142, v143
  s_waitcnt lgkmcnt(0)
  v_mfma_f32_32x32x16_bf16 v[144:159], v[176:179], v[96:99], 0
  v_mfma_f32_32x32x16_bf16 v[144:159], v[180:183], v[100:103], v[144:159]
  v_mfma_f32_32x32x16_bf16 v[160:175], v[176:179], v[104:107], 0
  v_mfma_f32_32x32x16_bf16 v[160:175], v[180:183], v[108:111], v[160:175]
  v_pk_add_f32 v[32:33], v[32:33], v[48:49]
  v_pk_add_f32 v[64:65], v[64:65], v[80:81]
  v_pk_add_f32 v[34:35], v[34:35], v[50:51]
  v_pk_add_f32 v[66:67], v[66:67], v[82:83]
  v_pk_add_f32 v[36:37], v[36:37], v[52:53]
  v_pk_add_f32 v[68:69], v[68:69], v[84:85]
  v_pk_add_f32 v[38:39], v[38:39], v[54:55]
  v_pk_add_f32 v[70:71], v[70:71], v[86:87]
  v_pk_add_f32 v[40:41], v[40:41], v[56:57]
  v_pk_add_f32 v[72:73], v[72:73], v[88:89]
  v_pk_add_f32 v[42:43], v[42:43], v[58:59]
  v_pk_add_f32 v[74:75], v[74:75], v[90:91]
  v_pk_add_f32 v[44:45], v[44:45], v[60:61]
  v_pk_add_f32 v[76:77], v[76:77], v[92:93]
  v_pk_add_f32 v[46:47], v[46:47], v[62:63]
  v_pk_add_f32 v[78:79], v[78:79], v[94:95]
  v_pk_add_f32 v[32:33], v[32:33], v[64:65]
  v_pk_add_f32 v[34:35], v[34:35], v[66:67]
  v_pk_add_f32 v[36:37], v[36:37], v[68:69]
  v_pk_add_f32 v[38:39], v[38:39], v[70:71]
  v_pk_add_f32 v[40:41], v[40:41], v[72:73]
  v_pk_add_f32 v[42:43], v[42:43], v[74:75]
  v_pk_add_f32 v[44:45], v[44:45], v[76:77]
  v_pk_add_f32 v[46:47], v[46:47], v[78:79]
  v_lshlrev_b32 v56, 16, v96
  v_and_b32 v57, 0xffff0000, v96
  v_pk_mul_f32 v[48:49], v[56:57], v[32:33]
  v_lshlrev_b32 v58, 16, v104
  v_and_b32 v59, 0xffff0000, v104
  v_pk_mul_f32 v[50:51], v[58:59], v[32:33]
  v_lshlrev_b32 v60, 16, v97
  v_and_b32 v61, 0xffff0000, v97
  v_pk_fma_f32 v[48:49], v[60:61], v[34:35], v[48:49]
  v_lshlrev_b32 v62, 16, v105
  v_and_b32 v63, 0xffff0000, v105
  v_pk_fma_f32 v[50:51], v[62:63], v[34:35], v[50:51]
  v_lshlrev_b32 v56, 16, v98
  v_and_b32 v57, 0xffff0000, v98
  v_pk_fma_f32 v[48:49], v[56:57], v[36:37], v[48:49]
  v_lshlrev_b32 v58, 16, v106
  v_and_b32 v59, 0xffff0000, v106
  v_pk_fma_f32 v[50:51], v[58:59], v[36:37], v[50:51]
  v_lshlrev_b32 v60, 16, v99
  v_and_b32 v61, 0xffff0000, v99
  v_pk_fma_f32 v[48:49], v[60:61], v[38:39], v[48:49]
  v_lshlrev_b32 v62, 16, v107
  v_and_b32 v63, 0xffff0000, v107
  v_pk_fma_f32 v[50:51], v[62:63], v[38:39], v[50:51]
  v_lshlrev_b32 v56, 16, v100
  v_and_b32 v57, 0xffff0000, v100
  v_pk_fma_f32 v[48:49], v[56:57], v[40:41], v[48:49]
  v_lshlrev_b32 v58, 16, v108
  v_and_b32 v59, 0xffff0000, v108
  v_pk_fma_f32 v[50:51], v[58:59], v[40:41], v[50:51]
  v_lshlrev_b32 v60, 16, v101
  v_and_b32 v61, 0xffff0000, v101
  v_pk_fma_f32 v[48:49], v[60:61], v[42:43], v[48:49]
  v_lshlrev_b32 v62, 16, v109
  v_and_b32 v63, 0xffff0000, v109
  v_pk_fma_f32 v[50:51], v[62:63], v[42:43], v[50:51]
  v_lshlrev_b32 v56, 16, v102
  v_and_b32 v57, 0xffff0000, v102
  v_pk_fma_f32 v[48:49], v[56:57], v[44:45], v[48:49]
  v_lshlrev_b32 v58, 16, v110
  v_and_b32 v59, 0xffff0000, v110
  v_pk_fma_f32 v[50:51], v[58:59], v[44:45], v[50:51]
  v_lshlrev_b32 v60, 16, v103
  v_and_b32 v61, 0xffff0000, v103
  v_pk_fma_f32 v[48:49], v[60:61], v[46:47], v[48:49]
  v_lshlrev_b32 v62, 16, v111
  v_and_b32 v63, 0xffff0000, v111
  v_pk_fma_f32 v[50:51], v[62:63], v[46:47], v[50:51]
  v_add_f32 v48, v48, v49
  v_add_f32 v50, v50, v51
  v_mov_b32 v49, v48
  v_mov_b32 v51, v50
  s_nop 1
  v_permlane32_swap_b32 v49, v48
  v_permlane32_swap_b32 v51, v50
  s_nop 1
  v_add_f32 v48, v48, v49
  v_add_f32 v48, s68, v48
  v_rcp_f32 v48, v48
  v_add_f32 v50, v50, v51
  v_add_f32 v50, s68, v50
  v_rcp_f32 v50, v50
  s_nop 0
  v_pk_mul_f32 v[144:145], v[144:145], v[48:49] op_sel_hi:[1,0]
  v_pk_mul_f32 v[146:147], v[146:147], v[48:49] op_sel_hi:[1,0]
  v_pk_mul_f32 v[148:149], v[148:149], v[48:49] op_sel_hi:[1,0]
  v_pk_mul_f32 v[150:151], v[150:151], v[48:49] op_sel_hi:[1,0]
  v_pk_mul_f32 v[152:153], v[152:153], v[48:49] op_sel_hi:[1,0]
  v_pk_mul_f32 v[154:155], v[154:155], v[48:49] op_sel_hi:[1,0]
  v_pk_mul_f32 v[156:157], v[156:157], v[48:49] op_sel_hi:[1,0]
  v_pk_mul_f32 v[158:159], v[158:159], v[48:49] op_sel_hi:[1,0]
  v_cvt_pk_bf16_f32 v64, v144, v145
  v_cvt_pk_bf16_f32 v65, v146, v147
  v_cvt_pk_bf16_f32 v66, v148, v149
  v_cvt_pk_bf16_f32 v67, v150, v151
  v_cvt_pk_bf16_f32 v68, v152, v153
  v_cvt_pk_bf16_f32 v69, v154, v155
  v_cvt_pk_bf16_f32 v70, v156, v157
  v_cvt_pk_bf16_f32 v71, v158, v159
  v_pk_mul_f32 v[160:161], v[160:161], v[50:51] op_sel_hi:[1,0]
  v_pk_mul_f32 v[162:163], v[162:163], v[50:51] op_sel_hi:[1,0]
  v_pk_mul_f32 v[164:165], v[164:165], v[50:51] op_sel_hi:[1,0]
  v_pk_mul_f32 v[166:167], v[166:167], v[50:51] op_sel_hi:[1,0]
  v_pk_mul_f32 v[168:169], v[168:169], v[50:51] op_sel_hi:[1,0]
  v_pk_mul_f32 v[170:171], v[170:171], v[50:51] op_sel_hi:[1,0]
  v_pk_mul_f32 v[172:173], v[172:173], v[50:51] op_sel_hi:[1,0]
  v_pk_mul_f32 v[174:175], v[174:175], v[50:51] op_sel_hi:[1,0]
  v_cvt_pk_bf16_f32 v72, v160, v161
  v_cvt_pk_bf16_f32 v73, v162, v163
  v_cvt_pk_bf16_f32 v74, v164, v165
  v_cvt_pk_bf16_f32 v75, v166, v167
  v_cvt_pk_bf16_f32 v76, v168, v169
  v_cvt_pk_bf16_f32 v77, v170, v171
  v_cvt_pk_bf16_f32 v78, v172, v173
  v_cvt_pk_bf16_f32 v79, v174, v175
  s_nop 1
  v_permlane32_swap_b32 v64, v66
  v_permlane32_swap_b32 v65, v67
  v_permlane32_swap_b32 v68, v70
  v_permlane32_swap_b32 v69, v71
  v_permlane32_swap_b32 v72, v74
  v_permlane32_swap_b32 v73, v75
  v_permlane32_swap_b32 v76, v78
  v_permlane32_swap_b32 v77, v79
  v_add_u32 v5, 0, v26
  v_xor_b32 v6, 32, v5
  ds_write_b128 v5, v[64:67] offset:0
  ds_write_b128 v6, v[68:71] offset:0
  ds_write_b128 v5, v[72:75] offset:4096
  ds_write_b128 v6, v[76:79] offset:4096
  s_mov_b32 s62, 24576
  s_mov_b32 s64, 0
  s_mov_b32 s63, 0
  s_waitcnt lgkmcnt(0)
  s_barrier
  ds_read_b128 v[32:35], v8 offset:0
  ds_read_b128 v[36:39], v8 offset:4096
  ds_read_b64_tr_b16 v[40:41], v12 offset:0
  ds_read_b64_tr_b16 v[42:43], v12 offset:512
  ds_read_b128 v[44:47], v9 offset:0
  ds_read_b128 v[48:51], v9 offset:4096
  ds_read_b64_tr_b16 v[52:53], v12 offset:2048
  ds_read_b64_tr_b16 v[54:55], v12 offset:2560
  ds_read_b128 v[56:59], v10 offset:0
  ds_read_b128 v[60:63], v10 offset:4096
  ds_read_b64_tr_b16 v[64:65], v12 offset:4096
  ds_read_b64_tr_b16 v[66:67], v12 offset:4608
  ds_read_b128 v[68:71], v11 offset:0
  ds_read_b128 v[72:75], v11 offset:4096
  ds_read_b64_tr_b16 v[76:77], v12 offset:6144
  ds_read_b64_tr_b16 v[78:79], v12 offset:6656
  s_add_u32 s64, s64, 1
  s_cmp_eq_u32 s64, 6
  s_cselect_b32 s65, 0xfffe2000, s62
  s_cselect_b32 s64, 0, s64
  v_add_u32 v8, s65, v8
  v_add_u32 v9, s65, v9
  v_add_u32 v10, s65, v10
  v_add_u32 v11, s65, v11
  v_add_u32 v12, s65, v12
  s_waitcnt lgkmcnt(0)
  v_mfma_f32_32x32x16_bf16 v[128:143], v[40:43], v[32:35], 0
  v_mfma_f32_32x32x16_bf16 v[144:159], v[40:43], v[36:39], 0
  v_mfma_f32_32x32x16_bf16 v[128:143], v[52:55], v[44:47], v[128:143]
  v_mfma_f32_32x32x16_bf16 v[144:159], v[52:55], v[48:51], v[144:159]
  v_mfma_f32_32x32x16_bf16 v[128:143], v[64:67], v[56:59], v[128:143]
  v_mfma_f32_32x32x16_bf16 v[144:159], v[64:67], v[60:63], v[144:159]
  v_mfma_f32_32x32x16_bf16 v[128:143], v[76:79], v[68:71], v[128:143]
  v_mfma_f32_32x32x16_bf16 v[144:159], v[76:79], v[72:75], v[144:159]
  s_barrier
  ds_read_b128 v[80:83], v8 offset:0
  ds_read_b128 v[84:87], v8 offset:4096
  ds_read_b64_tr_b16 v[88:89], v12 offset:0
  ds_read_b64_tr_b16 v[90:91], v12 offset:512
  ds_read_b128 v[92:95], v9 offset:0
  ds_read_b128 v[96:99], v9 offset:4096
  ds_read_b64_tr_b16 v[100:101], v12 offset:2048
  ds_read_b64_tr_b16 v[102:103], v12 offset:2560
  ds_read_b128 v[104:107], v10 offset:0
  ds_read_b128 v[108:111], v10 offset:4096
  ds_read_b64_tr_b16 v[112:113], v12 offset:4096
  ds_read_b64_tr_b16 v[114:115], v12 offset:4608
  ds_read_b128 v[116:119], v11 offset:0
  ds_read_b128 v[120:123], v11 offset:4096
  ds_read_b64_tr_b16 v[124:125], v12 offset:6144
  ds_read_b64_tr_b16 v[126:127], v12 offset:6656
  s_add_u32 s64, s64, 1
  s_cmp_eq_u32 s64, 6
  s_cselect_b32 s65, 0xfffe2000, s62
  s_cselect_b32 s64, 0, s64
  v_add_u32 v8, s65, v8
  v_add_u32 v9, s65, v9
  v_add_u32 v10, s65, v10
  v_add_u32 v11, s65, v11
  v_add_u32 v12, s65, v12
  s_mov_b32 s63, 1
  .p2align 6
L_g2loop:
  s_waitcnt lgkmcnt(0)
  s_cmp_eq_u32 s63, 15
  s_cbranch_scc1 L_g2last
  s_barrier
  v_mfma_f32_32x32x16_bf16 v[128:143], v[88:91], v[80:83], v[128:143]
  ds_read_b128 v[32:35], v8 offset:0
  ds_read_b128 v[36:39], v8 offset:4096
  v_mfma_f32_32x32x16_bf16 v[144:159], v[88:91], v[84:87], v[144:159]
  ds_read_b64_tr_b16 v[40:41], v12 offset:0
  ds_read_b64_tr_b16 v[42:43], v12 offset:512
  v_mfma_f32_32x32x16_bf16 v[128:143], v[100:103], v[92:95], v[128:143]
  ds_read_b128 v[44:47], v9 offset:0
  ds_read_b128 v[48:51], v9 offset:4096
  v_mfma_f32_32x32x16_bf16 v[144:159], v[100:103], v[96:99], v[144:159]
  ds_read_b64_tr_b16 v[52:53], v12 offset:2048
  ds_read_b64_tr_b16 v[54:55], v12 offset:2560
  v_mfma_f32_32x32x16_bf16 v[128:143], v[112:115], v[104:107], v[128:143]
  ds_read_b128 v[56:59], v10 offset:0
  ds_read_b128 v[60:63], v10 offset:4096
  v_mfma_f32_32x32x16_bf16 v[144:159], v[112:115], v[108:111], v[144:159]
  ds_read_b64_tr_b16 v[64:65], v12 offset:4096
  ds_read_b64_tr_b16 v[66:67], v12 offset:4608
  v_mfma_f32_32x32x16_bf16 v[128:143], v[124:127], v[116:119], v[128:143]
  ds_read_b128 v[68:71], v11 offset:0
  ds_read_b128 v[72:75], v11 offset:4096
  v_mfma_f32_32x32x16_bf16 v[144:159], v[124:127], v[120:123], v[144:159]
  ds_read_b64_tr_b16 v[76:77], v12 offset:6144
  ds_read_b64_tr_b16 v[78:79], v12 offset:6656
  s_add_u32 s64, s64, 1
  s_cmp_eq_u32 s64, 6
  s_cselect_b32 s65, 0xfffe2000, s62
  s_cselect_b32 s64, 0, s64
  v_add_u32 v8, s65, v8
  v_add_u32 v9, s65, v9
  v_add_u32 v10, s65, v10
  v_add_u32 v11, s65, v11
  v_add_u32 v12, s65, v12
  s_waitcnt lgkmcnt(0)
  s_barrier
  v_mfma_f32_32x32x16_bf16 v[128:143], v[40:43], v[32:35], v[128:143]
  ds_read_b128 v[80:83], v8 offset:0
  ds_read_b128 v[84:87], v8 offset:4096
  v_mfma_f32_32x32x16_bf16 v[144:159], v[40:43], v[36:39], v[144:159]
  ds_read_b64_tr_b16 v[88:89], v12 offset:0
  ds_read_b64_tr_b16 v[90:91], v12 offset:512
  v_mfma_f32_32x32x16_bf16 v[128:143], v[52:55], v[44:47], v[128:143]
  ds_read_b128 v[92:95], v9 offset:0
  ds_read_b128 v[96:99], v9 offset:4096
  v_mfma_f32_32x32x16_bf16 v[144:159], v[52:55], v[48:51], v[144:159]
  ds_read_b64_tr_b16 v[100:101], v12 offset:2048
  ds_read_b64_tr_b16 v[102:103], v12 offset:2560
  v_mfma_f32_32x32x16_bf16 v[128:143], v[64:67], v[56:59], v[128:143]
  ds_read_b128 v[104:107], v10 offset:0
  ds_read_b128 v[108:111], v10 offset:4096
  v_mfma_f32_32x32x16_bf16 v[144:159], v[64:67], v[60:63], v[144:159]
  ds_read_b64_tr_b16 v[112:113], v12 offset:4096
  ds_read_b64_tr_b16 v[114:115], v12 offset:4608
  v_mfma_f32_32x32x16_bf16 v[128:143], v[76:79], v[68:71], v[128:143]
  ds_read_b128 v[116:119], v11 offset:0
  ds_read_b128 v[120:123], v11 offset:4096
  v_mfma_f32_32x32x16_bf16 v[144:159], v[76:79], v[72:75], v[144:159]
  ds_read_b64_tr_b16 v[124:125], v12 offset:6144
  ds_read_b64_tr_b16 v[126:127], v12 offset:6656
  s_add_u32 s64, s64, 1
  s_cmp_eq_u32 s64, 6
  s_cselect_b32 s65, 0xfffe2000, s62
  s_cselect_b32 s64, 0, s64
  v_add_u32 v8, s65, v8
  v_add_u32 v9, s65, v9
  v_add_u32 v10, s65, v10
  v_add_u32 v11, s65, v11
  v_add_u32 v12, s65, v12
  s_add_u32 s63, s63, 2
  s_branch L_g2loop
L_g2last:
  v_mfma_f32_32x32x16_bf16 v[128:143], v[88:91], v[80:83], v[128:143]
  v_mfma_f32_32x32x16_bf16 v[144:159], v[88:91], v[84:87], v[144:159]
  v_mfma_f32_32x32x16_bf16 v[128:143], v[100:103], v[92:95], v[128:143]
  v_mfma_f32_32x32x16_bf16 v[144:159], v[100:103], v[96:99], v[144:159]
  v_mfma_f32_32x32x16_bf16 v[128:143], v[112:115], v[104:107], v[128:143]
  v_mfma_f32_32x32x16_bf16 v[144:159], v[112:115], v[108:111], v[144:159]
  v_mfma_f32_32x32x16_bf16 v[128:143], v[124:127], v[116:119], v[128:143]
  v_mfma_f32_32x32x16_bf16 v[144:159], v[124:127], v[120:123], v[144:159]
  s_barrier
  s_nop 7
  s_nop 3
  v_permlane32_swap_b32 v128, v132
  v_permlane32_swap_b32 v129, v133
  v_permlane32_swap_b32 v130, v134
  v_permlane32_swap_b32 v131, v135
  v_permlane32_swap_b32 v136, v140
  v_permlane32_swap_b32 v137, v141
  v_permlane32_swap_b32 v138, v142
  v_permlane32_swap_b32 v139, v143
  v_permlane32_swap_b32 v144, v148
  v_permlane32_swap_b32 v145, v149
  v_permlane32_swap_b32 v146, v150
  v_permlane32_swap_b32 v147, v151
  v_permlane32_swap_b32 v152, v156
  v_permlane32_swap_b32 v153, v157
  v_permlane32_swap_b32 v154, v158
  v_permlane32_swap_b32 v155, v159
  v_lshlrev_b32 v56, 16, v224
  v_and_b32 v57, 0xffff0000, v224
  v_pk_add_f32 v[128:129], v[128:129], v[56:57]
  v_pk_mul_f32 v[50:51], v[128:129], v[128:129]
  v_mov_b32 v48, v128
  v_mov_b32 v49, v129
  v_cvt_pk_bf16_f32 v224, v128, v129
  v_lshlrev_b32 v58, 16, v232
  v_and_b32 v59, 0xffff0000, v232
  v_pk_add_f32 v[144:145], v[144:145], v[58:59]
  v_pk_mul_f32 v[54:55], v[144:145], v[144:145]
  v_mov_b32 v52, v144
  v_mov_b32 v53, v145
  v_cvt_pk_bf16_f32 v232, v144, v145
  v_lshlrev_b32 v60, 16, v225
  v_and_b32 v61, 0xffff0000, v225
  v_pk_add_f32 v[130:131], v[130:131], v[60:61]
  v_pk_fma_f32 v[50:51], v[130:131], v[130:131], v[50:51]
  v_pk_add_f32 v[48:49], v[48:49], v[130:131]
  v_cvt_pk_bf16_f32 v225, v130, v131
  v_lshlrev_b32 v62, 16, v233
  v_and_b32 v63, 0xffff0000, v233
  v_pk_add_f32 v[146:147], v[146:147], v[62:63]
  v_pk_fma_f32 v[54:55], v[146:147], v[146:147], v[54:55]
  v_pk_add_f32 v[52:53], v[52:53], v[146:147]
  v_cvt_pk_bf16_f32 v233, v146, v147
  v_lshlrev_b32 v56, 16, v226
  v_and_b32 v57, 0xffff0000, v226
  v_pk_add_f32 v[132:133], v[132:133], v[56:57]
  v_pk_fma_f32 v[50:51], v[132:133], v[132:133], v[50:51]
  v_pk_add_f32 v[48:49], v[48:49], v[132:133]
  v_cvt_pk_bf16_f32 v226, v132, v133
  v_lshlrev_b32 v58, 16, v234
  v_and_b32 v59, 0xffff0000, v234
  v_pk_add_f32 v[148:149], v[148:149], v[58:59]
  v_pk_fma_f32 v[54:55], v[148:149], v[148:149], v[54:55]
  v_pk_add_f32 v[52:53], v[52:53], v[148:149]
  v_cvt_pk_bf16_f32 v234, v148, v149
  v_lshlrev_b32 v60, 16, v227
  v_and_b32 v61, 0xffff0000, v227
  v_pk_add_f32 v[134:135], v[134:135], v[60:61]
  v_pk_fma_f32 v[50:51], v[134:135], v[134:135], v[50:51]
  v_pk_add_f32 v[48:49], v[48:49], v[134:135]
  v_cvt_pk_bf16_f32 v227, v134, v135
  v_lshlrev_b32 v62, 16, v235
  v_and_b32 v63, 0xffff0000, v235
  v_pk_add_f32 v[150:151], v[150:151], v[62:63]
  v_pk_fma_f32 v[54:55], v[150:151], v[150:151], v[54:55]
  v_pk_add_f32 v[52:53], v[52:53], v[150:151]
  v_cvt_pk_bf16_f32 v235, v150, v151
  v_lshlrev_b32 v56, 16, v228
  v_and_b32 v57, 0xffff0000, v228
  v_pk_add_f32 v[136:137], v[136:137], v[56:57]
  v_pk_fma_f32 v[50:51], v[136:137], v[136:137], v[50:51]
  v_pk_add_f32 v[48:49], v[48:49], v[136:137]
  v_cvt_pk_bf16_f32 v228, v136, v137
  v_lshlrev_b32 v58, 16, v236
  v_and_b32 v59, 0xffff0000, v236
  v_pk_add_f32 v[152:153], v[152:153], v[58:59]
  v_pk_fma_f32 v[54:55], v[152:153], v[152:153], v[54:55]
  v_pk_add_f32 v[52:53], v[52:53], v[152:153]
  v_cvt_pk_bf16_f32 v236, v152, v153
  v_lshlrev_b32 v60, 16, v229
  v_and_b32 v61, 0xffff0000, v229
  v_pk_add_f32 v[138:139], v[138:139], v[60:61]
  v_pk_fma_f32 v[50:51], v[138:139], v[138:139], v[50:51]
  v_pk_add_f32 v[48:49], v[48:49], v[138:139]
  v_cvt_pk_bf16_f32 v229, v138, v139
  v_lshlrev_b32 v62, 16, v237
  v_and_b32 v63, 0xffff0000, v237
  v_pk_add_f32 v[154:155], v[154:155], v[62:63]
  v_pk_fma_f32 v[54:55], v[154:155], v[154:155], v[54:55]
  v_pk_add_f32 v[52:53], v[52:53], v[154:155]
  v_cvt_pk_bf16_f32 v237, v154, v155
  v_lshlrev_b32 v56, 16, v230
  v_and_b32 v57, 0xffff0000, v230
  v_pk_add_f32 v[140:141], v[140:141], v[56:57]
  v_pk_fma_f32 v[50:51], v[140:141], v[140:141], v[50:51]
  v_pk_add_f32 v[48:49], v[48:49], v[140:141]
  v_cvt_pk_bf16_f32 v230, v140, v141
  v_lshlrev_b32 v58, 16, v238
  v_and_b32 v59, 0xffff0000, v238
  v_pk_add_f32 v[156:157], v[156:157], v[58:59]
  v_pk_fma_f32 v[54:55], v[156:157], v[156:157], v[54:55]
  v_pk_add_f32 v[52:53], v[52:53], v[156:157]
  v_cvt_pk_bf16_f32 v238, v156, v157
  v_lshlrev_b32 v60, 16, v231
  v_and_b32 v61, 0xffff0000, v231
  v_pk_add_f32 v[142:143], v[142:143], v[60:61]
  v_pk_fma_f32 v[50:51], v[142:143], v[142:143], v[50:51]
  v_pk_add_f32 v[48:49], v[48:49], v[142:143]
  v_cvt_pk_bf16_f32 v231, v142, v143
  v_lshlrev_b32 v62, 16, v239
  v_and_b32 v63, 0xffff0000, v239
  v_pk_add_f32 v[158:159], v[158:159], v[62:63]
  v_pk_fma_f32 v[54:55], v[158:159], v[158:159], v[54:55]
  v_pk_add_f32 v[52:53], v[52:53], v[158:159]
  v_cvt_pk_bf16_f32 v239, v158, v159
  s_cmp_eq_u32 s53, 1
  s_cbranch_scc1 L_final
  v_add_f32 v40, v48, v49
  v_add_f32 v41, v50, v51
  v_add_f32 v42, v52, v53
  v_add_f32 v43, v54, v55
  v_mov_b32 v44, v40
  v_mov_b32 v45, v41
  v_mov_b32 v46, v42
  v_mov_b32 v47, v43
  s_lshl_b32 s60, s51, 9
  s_lshl_b32 s61, s52, 10
  v_permlane32_swap_b32 v44, v40
  v_permlane32_swap_b32 v45, v41
  v_permlane32_swap_b32 v46, v42
  v_permlane32_swap_b32 v47, v43
  v_cmp_eq_u32 vcc, 1, v3
  s_add_u32 s60, s60, s61
  s_add_u32 s60, s60, 57344
  v_add_f32 v40, v40, v44
  v_add_f32 v41, v41, v45
  v_add_f32 v42, v42, v46
  v_add_f32 v43, v43, v47
  v_cndmask_b32 v48, v40, v42, vcc
  v_cndmask_b32 v49, v41, v43, vcc
  v_lshlrev_b32 v7, 3, v1
  v_add_u32 v7, s60, v7
  ds_write_b64 v7, v[48:49]
  s_waitcnt lgkmcnt(0)
  s_barrier
  s_barrier
  s_lshl_b32 s60, s48, 14
  s_lshl_b32 s61, s51, 9
  s_add_u32 s60, s60, s61
  s_add_u32 s60, s60, 0x2000000
  v_lshlrev_b32 v5, 13, v3
  v_lshl_add_u32 v5, v2, 3, v5
  buffer_load_dwordx2 v[64:65], v5, s[8:11], s60 offen offset:0 sc1
  buffer_load_dwordx2 v[80:81], v5, s[8:11], s60 offen offset:256 sc1
  s_add_u32 s60, s60, 1024
  buffer_load_dwordx2 v[66:67], v5, s[8:11], s60 offen offset:0 sc1
  buffer_load_dwordx2 v[82:83], v5, s[8:11], s60 offen offset:256 sc1
  s_add_u32 s60, s60, 1024
  buffer_load_dwordx2 v[68:69], v5, s[8:11], s60 offen offset:0 sc1
  buffer_load_dwordx2 v[84:85], v5, s[8:11], s60 offen offset:256 sc1
  s_add_u32 s60, s60, 1024
  buffer_load_dwordx2 v[70:71], v5, s[8:11], s60 offen offset:0 sc1
  buffer_load_dwordx2 v[86:87], v5, s[8:11], s60 offen offset:256 sc1
  s_add_u32 s60, s60, 1024
  buffer_load_dwordx2 v[72:73], v5, s[8:11], s60 offen offset:0 sc1
  buffer_load_dwordx2 v[88:89], v5, s[8:11], s60 offen offset:256 sc1
  s_add_u32 s60, s60, 1024
  buffer_load_dwordx2 v[74:75], v5, s[8:11], s60 offen offset:0 sc1
  buffer_load_dwordx2 v[90:91], v5, s[8:11], s60 offen offset:256 sc1
  s_add_u32 s60, s60, 1024
  buffer_load_dwordx2 v[76:77], v5, s[8:11], s60 offen offset:0 sc1
  buffer_load_dwordx2 v[92:93], v5, s[8:11], s60 offen offset:256 sc1
  s_add_u32 s60, s60, 1024
  buffer_load_dwordx2 v[78:79], v5, s[8:11], s60 offen offset:0 sc1
  buffer_load_dwordx2 v[94:95], v5, s[8:11], s60 offen offset:256 sc1
  s_mov_b32 s53, 1
  s_mov_b32 s55, 0x2100000
  s_mov_b32 s56, 0x1a00000
  s_waitcnt vmcnt(0)
  v_pk_add_f32 v[64:65], v[64:65], v[66:67]
  v_pk_add_f32 v[80:81], v[80:81], v[82:83]
  v_pk_add_f32 v[64:65], v[64:65], v[68:69]
  v_pk_add_f32 v[80:81], v[80:81], v[84:85]
  v_pk_add_f32 v[64:65], v[64:65], v[70:71]
  v_pk_add_f32 v[80:81], v[80:81], v[86:87]
  v_pk_add_f32 v[64:65], v[64:65], v[72:73]
  v_pk_add_f32 v[80:81], v[80:81], v[88:89]
  v_pk_add_f32 v[64:65], v[64:65], v[74:75]
  v_pk_add_f32 v[80:81], v[80:81], v[90:91]
  v_pk_add_f32 v[64:65], v[64:65], v[76:77]
  v_pk_add_f32 v[80:81], v[80:81], v[92:93]
  v_pk_add_f32 v[64:65], v[64:65], v[78:79]
  v_pk_add_f32 v[80:81], v[80:81], v[94:95]
  v_mov_b32 v66, v64
  v_mov_b32 v67, v65
  v_mov_b32 v82, v80
  v_mov_b32 v83, v81
  s_mov_b32 s60, 0x3a800000
  s_mov_b32 s61, 0x3727c5ac
  v_permlane32_swap_b32 v66, v64
  v_permlane32_swap_b32 v67, v65
  v_permlane32_swap_b32 v82, v80
  v_permlane32_swap_b32 v83, v81
  s_nop 0
  v_pk_add_f32 v[64:65], v[64:65], v[66:67]
  v_pk_add_f32 v[80:81], v[80:81], v[82:83]
  v_mul_f32 v16, s60, v64
  v_mul_f32 v65, s60, v65
  v_mul_f32 v18, s60, v80
  v_mul_f32 v81, s60, v81
  v_fma_f32 v65, -v16, v16, v65
  v_max_f32 v65, 0, v65
  v_add_f32 v65, s61, v65
  v_rsq_f32 v20, v65
  v_fma_f32 v81, -v18, v18, v81
  v_max_f32 v81, 0, v81
  v_add_f32 v81, s61, v81
  v_rsq_f32 v22, v81
  s_nop 0
  s_branch L_etail
L_final:
  v_add_u32 v5, 81920, v26
  v_xor_b32 v6, 32, v5
  ds_write_b128 v5, v[224:227] offset:0
  ds_write_b128 v6, v[228:231] offset:0
  ds_write_b128 v5, v[232:235] offset:4096
  ds_write_b128 v6, v[236:239] offset:4096
  s_waitcnt lgkmcnt(0)
  s_barrier
  s_endpgm
L_helper:
  s_sub_u32 s70, s50, 4
  s_waitcnt vmcnt(0)
  s_barrier
  s_cmp_eq_u32 s50, 4
  s_cbranch_scc0 interleave_layers__ssm_conv_h3__linear_attn_block__prompt_kernel_nm1
  v_cmp_eq_u32 vcc, 0, v1
  s_and_saveexec_b64 s[90:91], vcc
  s_lshl_b32 s62, s48, 2
  s_lshl_b32 s63, s49, 2
  s_add_u32 s63, s63, 64
  v_mov_b32 v5, s62
  v_mov_b32 v6, s63
  s_mov_b32 s61, 0
interleave_layers__ssm_conv_h3__linear_attn_block__prompt_kernel_pw2:
  buffer_load_dword v8, v5, s[44:47], 0 offen sc1
  buffer_load_dword v9, v6, s[44:47], 0 offen sc1
  s_add_u32 s61, s61, 1
  s_cmp_gt_u32 s61, 0x40000
  s_cbranch_scc1 interleave_layers__ssm_conv_h3__linear_attn_block__prompt_kernel_pwe3
  s_waitcnt vmcnt(0)
  v_xor_b32 v8, 1, v8
  v_xor_b32 v9, 1, v9
  v_or_b32 v8, v8, v9
  v_cmp_ne_u32 vcc, 0, v8
  s_cbranch_vccnz interleave_layers__ssm_conv_h3__linear_attn_block__prompt_kernel_pw2
interleave_layers__ssm_conv_h3__linear_attn_block__prompt_kernel_pwe3:
  v_mov_b32 v10, 1
  s_add_u32 s62, s59, 0
  v_mov_b32 v11, s62
  buffer_atomic_add v10, v11, s[8:11], 0 offen sc1
  s_add_u32 s62, s59, 0
  v_mov_b32 v5, s62
  s_mov_b32 s61, 0
interleave_layers__ssm_conv_h3__linear_attn_block__prompt_kernel_pw4:
  buffer_load_dword v8, v5, s[8:11], 0 offen sc1
  s_add_u32 s61, s61, 1
  s_cmp_gt_u32 s61, 0x40000
  s_cbranch_scc1 interleave_layers__ssm_conv_h3__linear_attn_block__prompt_kernel_pwe5
  s_waitcnt vmcnt(0)
  v_xor_b32 v8, 16, v8
  v_cmp_ne_u32 vcc, 0, v8
  s_cbranch_vccnz interleave_layers__ssm_conv_h3__linear_attn_block__prompt_kernel_pw4
interleave_layers__ssm_conv_h3__linear_attn_block__prompt_kernel_pwe5:
  s_mov_b64 exec, s[90:91]
interleave_layers__ssm_conv_h3__linear_attn_block__prompt_kernel_nm1:
  v_lshrrev_b32 v5, 3, v1
  v_and_b32 v6, 7, v1
  v_lshrrev_b32 v7, 4, v1
  s_lshl_b32 s60, s48, 18
  s_lshl_b32 s61, s70, 16
  s_add_u32 s60, s60, s61
  v_xor_b32 v8, 0, v7
  v_xor_b32 v8, v8, v6
  v_lshlrev_b32 v8, 4, v8
  v_add_u32 v9, 0, v5
  v_lshl_add_u32 v8, v9, 11, v8
  v_add_u32 v16, s60, v8
  v_xor_b32 v8, 4, v7
  v_xor_b32 v8, v8, v6
  v_lshlrev_b32 v8, 4, v8
  v_add_u32 v9, 8, v5
  v_lshl_add_u32 v8, v9, 11, v8
  v_add_u32 v17, s60, v8
  v_xor_b32 v8, 0, v7
  v_xor_b32 v8, v8, v6
  v_lshlrev_b32 v8, 4, v8
  v_add_u32 v9, 16, v5
  v_lshl_add_u32 v8, v9, 11, v8
  v_add_u32 v18, s60, v8
  v_xor_b32 v8, 4, v7
  v_xor_b32 v8, v8, v6
  v_lshlrev_b32 v8, 4, v8
  v_add_u32 v9, 24, v5
  v_lshl_add_u32 v8, v9, 11, v8
  v_add_u32 v19, s60, v8
  s_lshl_b32 s60, s70, 12
  v_lshlrev_b32 v24, 4, v1
  v_add_u32 v24, s60, v24
  v_bfe_u32 v8, v1, 4, 1
  v_lshlrev_b32 v8, 2, v8
  v_xor_b32 v8, v8, v6
  v_lshlrev_b32 v8, 4, v8
  s_movk_i32 s60, 6144
  v_mul_lo_u32 v9, v5, s60
  v_add_u32 v9, v9, v8
  s_lshl_b32 s61, s49, 7
  s_mul_i32 s62, s70, 6
  s_add_u32 s62, s62, 0
  s_lshr_b32 s63, s62, 3
  s_and_b32 s64, s62, 7
  s_lshl_b32 s63, s63, 11
  s_mul_i32 s64, s64, 49152
  s_add_u32 s63, s63, s64
  s_add_u32 s63, s63, s61
  v_add_u32 v216, s63, v9
  s_mul_i32 s62, s70, 6
  s_add_u32 s62, s62, 1
  s_lshr_b32 s63, s62, 3
  s_and_b32 s64, s62, 7
  s_lshl_b32 s63, s63, 11
  s_mul_i32 s64, s64, 49152
  s_add_u32 s63, s63, s64
  s_add_u32 s63, s63, s61
  v_add_u32 v217, s63, v9
  s_mul_i32 s62, s70, 6
  s_add_u32 s62, s62, 2
  s_lshr_b32 s63, s62, 3
  s_and_b32 s64, s62, 7
  s_lshl_b32 s63, s63, 11
  s_mul_i32 s64, s64, 49152
  s_add_u32 s63, s63, s64
  s_add_u32 s63, s63, s61
  v_add_u32 v218, s63, v9
  s_mul_i32 s62, s70, 6
  s_add_u32 s62, s62, 3
  s_lshr_b32 s63, s62, 3
  s_and_b32 s64, s62, 7
  s_lshl_b32 s63, s63, 11
  s_mul_i32 s64, s64, 49152
  s_add_u32 s63, s63, s64
  s_add_u32 s63, s63, s61
  v_add_u32 v219, s63, v9
  s_mul_i32 s62, s70, 6
  s_add_u32 s62, s62, 4
  s_lshr_b32 s63, s62, 3
  s_and_b32 s64, s62, 7
  s_lshl_b32 s63, s63, 11
  s_mul_i32 s64, s64, 49152
  s_add_u32 s63, s63, s64
  s_add_u32 s63, s63, s61
  v_add_u32 v220, s63, v9
  s_mul_i32 s62, s70, 6
  s_add_u32 s62, s62, 5
  s_lshr_b32 s63, s62, 3
  s_and_b32 s64, s62, 7
  s_lshl_b32 s63, s63, 11
  s_mul_i32 s64, s64, 49152
  s_add_u32 s63, s63, s64
  s_add_u32 s63, s63, s61
  v_add_u32 v221, s63, v9
  v_lshl_add_u32 v9, v5, 11, v8
  s_lshl_b32 s62, s70, 1
  s_add_u32 s62, s62, 0
  s_lshl_b32 s62, s62, 14
  s_add_u32 s62, s62, s61
  v_add_u32 v20, s62, v9
  s_lshl_b32 s62, s70, 1
  s_add_u32 s62, s62, 1
  s_lshl_b32 s62, s62, 14
  s_add_u32 s62, s62, s61
  v_add_u32 v21, s62, v9
  s_lshl_b32 s71, s70, 12
  s_mul_i32 s72, s70, 6144
  s_add_u32 s72, s72, 16384
  s_lshl_b32 s73, s70, 11
  s_add_u32 s73, s73, 16384
  s_lshl_b32 s79, s49, 7
  s_barrier
  s_barrier
  v_lshrrev_b32 v176, 1, v1
  v_and_b32 v177, 1, v1
  v_lshlrev_b32 v178, 11, v176
  v_lshl_add_u32 v178, v177, 6, v178
  s_lshl_b32 s60, s48, 18
  s_lshl_b32 s61, s70, 16
  s_add_u32 s60, s60, s61
  s_add_u32 s60, s60, s79
  buffer_load_dwordx4 v[128:131], v178, s[20:23], s60 offen offset:0
  buffer_load_dwordx4 v[132:135], v178, s[20:23], s60 offen offset:16
  buffer_load_dwordx4 v[136:139], v178, s[20:23], s60 offen offset:32
  buffer_load_dwordx4 v[140:143], v178, s[20:23], s60 offen offset:48
  v_lshrrev_b32 v179, 3, v1
  v_and_b32 v180, 7, v1
  s_movk_i32 s65, 6144
  v_lshlrev_b32 v181, 3, v179
  v_mul_lo_u32 v181, v181, s65
  v_lshl_add_u32 v181, v180, 4, v181
  s_mul_i32 s66, s48, 393216
  s_add_u32 s66, s66, s79
  s_min_u32 s67, s70, 2
  s_lshl_b32 s67, s67, 11
  s_add_u32 s66, s66, s67
  buffer_load_dwordx4 v[144:147], v181, s[28:31], s66 offen
  s_add_u32 s66, s66, 6144
  buffer_load_dwordx4 v[148:151], v181, s[28:31], s66 offen
  s_add_u32 s66, s66, 6144
  buffer_load_dwordx4 v[152:155], v181, s[28:31], s66 offen
  s_add_u32 s66, s66, 6144
  buffer_load_dwordx4 v[156:159], v181, s[28:31], s66 offen
  s_add_u32 s66, s66, 6144
  buffer_load_dwordx4 v[160:163], v181, s[28:31], s66 offen
  s_add_u32 s66, s66, 6144
  buffer_load_dwordx4 v[164:167], v181, s[28:31], s66 offen
  s_add_u32 s66, s66, 6144
  buffer_load_dwordx4 v[168:171], v181, s[28:31], s66 offen
  s_add_u32 s66, s66, 6144
  buffer_load_dwordx4 v[172:175], v181, s[28:31], s66 offen
  s_mov_b32 s75, s49
  s_mul_i32 s77, s75, 393216
  s_add_u32 m0, s72, 81920
  s_nop 0
  buffer_load_dwordx4 v216, s[28:31], s77 offen lds
  s_add_u32 m0, m0, 1024
  s_nop 0
  buffer_load_dwordx4 v217, s[28:31], s77 offen lds
  s_add_u32 m0, m0, 1024
  s_nop 0
  buffer_load_dwordx4 v218, s[28:31], s77 offen lds
  s_add_u32 m0, m0, 1024
  s_nop 0
  buffer_load_dwordx4 v219, s[28:31], s77 offen lds
  s_add_u32 m0, m0, 1024
  s_nop 0
  buffer_load_dwordx4 v220, s[28:31], s77 offen lds
  s_add_u32 m0, m0, 1024
  s_nop 0
  buffer_load_dwordx4 v221, s[28:31], s77 offen lds
  s_add_u32 s75, s75, 1
  s_and_b32 s75, s75, 15
  s_mul_i32 s77, s75, 393216
  s_add_u32 m0, s72, 122880
  s_nop 0
  buffer_load_dwordx4 v216, s[28:31], s77 offen lds
  s_add_u32 m0, m0, 1024
  s_nop 0
  buffer_load_dwordx4 v217, s[28:31], s77 offen lds
  s_add_u32 m0, m0, 1024
  s_nop 0
  buffer_load_dwordx4 v218, s[28:31], s77 offen lds
  s_add_u32 m0, m0, 1024
  s_nop 0
  buffer_load_dwordx4 v219, s[28:31], s77 offen lds
  s_add_u32 m0, m0, 1024
  s_nop 0
  buffer_load_dwordx4 v220, s[28:31], s77 offen lds
  s_add_u32 m0, m0, 1024
  s_nop 0
  buffer_load_dwordx4 v221, s[28:31], s77 offen lds
  s_add_u32 s75, s75, 1
  s_and_b32 s75, s75, 15
  v_lshlrev_b32 v182, 11, v179
  v_lshl_add_u32 v182, v180, 4, v182
  s_lshl_b32 s66, s48, 17
  s_lshl_b32 s67, s70, 15
  s_add_u32 s66, s66, s67
  s_add_u32 s66, s66, s79
  buffer_load_dwordx4 v[208:211], v182, s[32:35], s66 offen
  s_add_u32 s66, s66, 16384
  buffer_load_dwordx4 v[212:215], v182, s[32:35], s66 offen
  s_waitcnt vmcnt(22)
  v_lshlrev_b32 v56, 16, v128
  v_and_b32 v57, 0xffff0000, v128
  v_pk_mul_f32 v[50:51], v[56:57], v[56:57]
  v_mov_b32 v48, v56
  v_mov_b32 v49, v57
  v_lshlrev_b32 v58, 16, v129
  v_and_b32 v59, 0xffff0000, v129
  v_pk_mul_f32 v[54:55], v[58:59], v[58:59]
  v_mov_b32 v52, v58
  v_mov_b32 v53, v59
  v_lshlrev_b32 v60, 16, v130
  v_and_b32 v61, 0xffff0000, v130
  v_pk_fma_f32 v[50:51], v[60:61], v[60:61], v[50:51]
  v_pk_add_f32 v[48:49], v[48:49], v[60:61]
  v_lshlrev_b32 v62, 16, v131
  v_and_b32 v63, 0xffff0000, v131
  v_pk_fma_f32 v[54:55], v[62:63], v[62:63], v[54:55]
  v_pk_add_f32 v[52:53], v[52:53], v[62:63]
  v_lshlrev_b32 v56, 16, v132
  v_and_b32 v57, 0xffff0000, v132
  v_pk_fma_f32 v[50:51], v[56:57], v[56:57], v[50:51]
  v_pk_add_f32 v[48:49], v[48:49], v[56:57]
  v_lshlrev_b32 v58, 16, v133
  v_and_b32 v59, 0xffff0000, v133
  v_pk_fma_f32 v[54:55], v[58:59], v[58:59], v[54:55]
  v_pk_add_f32 v[52:53], v[52:53], v[58:59]
  v_lshlrev_b32 v60, 16, v134
  v_and_b32 v61, 0xffff0000, v134
  v_pk_fma_f32 v[50:51], v[60:61], v[60:61], v[50:51]
  v_pk_add_f32 v[48:49], v[48:49], v[60:61]
  v_lshlrev_b32 v62, 16, v135
  v_and_b32 v63, 0xffff0000, v135
  v_pk_fma_f32 v[54:55], v[62:63], v[62:63], v[54:55]
  v_pk_add_f32 v[52:53], v[52:53], v[62:63]
  v_lshlrev_b32 v56, 16, v136
  v_and_b32 v57, 0xffff0000, v136
  v_pk_fma_f32 v[50:51], v[56:57], v[56:57], v[50:51]
  v_pk_add_f32 v[48:49], v[48:49], v[56:57]
  v_lshlrev_b32 v58, 16, v137
  v_and_b32 v59, 0xffff0000, v137
  v_pk_fma_f32 v[54:55], v[58:59], v[58:59], v[54:55]
  v_pk_add_f32 v[52:53], v[52:53], v[58:59]
  v_lshlrev_b32 v60, 16, v138
  v_and_b32 v61, 0xffff0000, v138
  v_pk_fma_f32 v[50:51], v[60:61], v[60:61], v[50:51]
  v_pk_add_f32 v[48:49], v[48:49], v[60:61]
  v_lshlrev_b32 v62, 16, v139
  v_and_b32 v63, 0xffff0000, v139
  v_pk_fma_f32 v[54:55], v[62:63], v[62:63], v[54:55]
  v_pk_add_f32 v[52:53], v[52:53], v[62:63]
  v_lshlrev_b32 v56, 16, v140
  v_and_b32 v57, 0xffff0000, v140
  v_pk_fma_f32 v[50:51], v[56:57], v[56:57], v[50:51]
  v_pk_add_f32 v[48:49], v[48:49], v[56:57]
  v_lshlrev_b32 v58, 16, v141
  v_and_b32 v59, 0xffff0000, v141
  v_pk_fma_f32 v[54:55], v[58:59], v[58:59], v[54:55]
  v_pk_add_f32 v[52:53], v[52:53], v[58:59]
  v_lshlrev_b32 v60, 16, v142
  v_and_b32 v61, 0xffff0000, v142
  v_pk_fma_f32 v[50:51], v[60:61], v[60:61], v[50:51]
  v_pk_add_f32 v[48:49], v[48:49], v[60:61]
  v_lshlrev_b32 v62, 16, v143
  v_and_b32 v63, 0xffff0000, v143
  v_pk_fma_f32 v[54:55], v[62:63], v[62:63], v[54:55]
  v_pk_add_f32 v[52:53], v[52:53], v[62:63]
  v_pk_add_f32 v[48:49], v[48:49], v[52:53]
  v_pk_add_f32 v[50:51], v[50:51], v[54:55]
  v_add_f32 v44, v48, v49
  v_add_f32 v45, v50, v51
  s_lshl_b32 s60, s48, 4
  s_add_u32 s60, s60, s49
  v_add_f32_dpp v44, v44, v44 quad_perm:[1,0,3,2] row_mask:0xf bank_mask:0xf
  v_add_f32_dpp v45, v45, v45 quad_perm:[1,0,3,2] row_mask:0xf bank_mask:0xf
  s_lshl_b32 s60, s60, 10
  s_lshl_b32 s61, s70, 8
  s_add_u32 s60, s60, s61
  s_add_u32 s60, s60, 0x1e00000
  v_lshlrev_b32 v46, 3, v176
  v_cmp_eq_u32 vcc, 0, v177
  s_and_saveexec_b64 s[90:91], vcc
  buffer_store_dwordx2 v[44:45], v46, s[8:11], s60 offen sc1
  s_mov_b64 exec, s[90:91]
  s_cmp_eq_u32 s70, 3
  s_cbranch_scc1 L_nocs
  s_waitcnt vmcnt(15)
  v_lshlrev_b32 v190, 16, v144
  v_and_b32 v191, 0xffff0000, v144
  v_lshlrev_b32 v186, 16, v148
  v_and_b32 v187, 0xffff0000, v148
  v_pk_add_f32 v[190:191], v[190:191], v[186:187]
  v_lshlrev_b32 v188, 16, v152
  v_and_b32 v189, 0xffff0000, v152
  v_pk_add_f32 v[190:191], v[190:191], v[188:189]
  v_lshlrev_b32 v184, 16, v156
  v_and_b32 v185, 0xffff0000, v156
  v_pk_add_f32 v[190:191], v[190:191], v[184:185]
  v_lshlrev_b32 v186, 16, v160
  v_and_b32 v187, 0xffff0000, v160
  v_pk_add_f32 v[190:191], v[190:191], v[186:187]
  v_lshlrev_b32 v188, 16, v164
  v_and_b32 v189, 0xffff0000, v164
  v_pk_add_f32 v[190:191], v[190:191], v[188:189]
  v_lshlrev_b32 v184, 16, v168
  v_and_b32 v185, 0xffff0000, v168
  v_pk_add_f32 v[190:191], v[190:191], v[184:185]
  v_lshlrev_b32 v186, 16, v172
  v_and_b32 v187, 0xffff0000, v172
  v_pk_add_f32 v[190:191], v[190:191], v[186:187]
  v_lshlrev_b32 v192, 16, v145
  v_and_b32 v193, 0xffff0000, v145
  v_lshlrev_b32 v186, 16, v149
  v_and_b32 v187, 0xffff0000, v149
  v_pk_add_f32 v[192:193], v[192:193], v[186:187]
  v_lshlrev_b32 v188, 16, v153
  v_and_b32 v189, 0xffff0000, v153
  v_pk_add_f32 v[192:193], v[192:193], v[188:189]
  v_lshlrev_b32 v184, 16, v157
  v_and_b32 v185, 0xffff0000, v157
  v_pk_add_f32 v[192:193], v[192:193], v[184:185]
  v_lshlrev_b32 v186, 16, v161
  v_and_b32 v187, 0xffff0000, v161
  v_pk_add_f32 v[192:193], v[192:193], v[186:187]
  v_lshlrev_b32 v188, 16, v165
  v_and_b32 v189, 0xffff0000, v165
  v_pk_add_f32 v[192:193], v[192:193], v[188:189]
  v_lshlrev_b32 v184, 16, v169
  v_and_b32 v185, 0xffff0000, v169
  v_pk_add_f32 v[192:193], v[192:193], v[184:185]
  v_lshlrev_b32 v186, 16, v173
  v_and_b32 v187, 0xffff0000, v173
  v_pk_add_f32 v[192:193], v[192:193], v[186:187]
  v_lshlrev_b32 v194, 16, v146
  v_and_b32 v195, 0xffff0000, v146
  v_lshlrev_b32 v186, 16, v150
  v_and_b32 v187, 0xffff0000, v150
  v_pk_add_f32 v[194:195], v[194:195], v[186:187]
  v_lshlrev_b32 v188, 16, v154
  v_and_b32 v189, 0xffff0000, v154
  v_pk_add_f32 v[194:195], v[194:195], v[188:189]
  v_lshlrev_b32 v184, 16, v158
  v_and_b32 v185, 0xffff0000, v158
  v_pk_add_f32 v[194:195], v[194:195], v[184:185]
  v_lshlrev_b32 v186, 16, v162
  v_and_b32 v187, 0xffff0000, v162
  v_pk_add_f32 v[194:195], v[194:195], v[186:187]
  v_lshlrev_b32 v188, 16, v166
  v_and_b32 v189, 0xffff0000, v166
  v_pk_add_f32 v[194:195], v[194:195], v[188:189]
  v_lshlrev_b32 v184, 16, v170
  v_and_b32 v185, 0xffff0000, v170
  v_pk_add_f32 v[194:195], v[194:195], v[184:185]
  v_lshlrev_b32 v186, 16, v174
  v_and_b32 v187, 0xffff0000, v174
  v_pk_add_f32 v[194:195], v[194:195], v[186:187]
  v_lshlrev_b32 v196, 16, v147
  v_and_b32 v197, 0xffff0000, v147
  v_lshlrev_b32 v186, 16, v151
  v_and_b32 v187, 0xffff0000, v151
  v_pk_add_f32 v[196:197], v[196:197], v[186:187]
  v_lshlrev_b32 v188, 16, v155
  v_and_b32 v189, 0xffff0000, v155
  v_pk_add_f32 v[196:197], v[196:197], v[188:189]
  v_lshlrev_b32 v184, 16, v159
  v_and_b32 v185, 0xffff0000, v159
  v_pk_add_f32 v[196:197], v[196:197], v[184:185]
  v_lshlrev_b32 v186, 16, v163
  v_and_b32 v187, 0xffff0000, v163
  v_pk_add_f32 v[196:197], v[196:197], v[186:187]
  v_lshlrev_b32 v188, 16, v167
  v_and_b32 v189, 0xffff0000, v167
  v_pk_add_f32 v[196:197], v[196:197], v[188:189]
  v_lshlrev_b32 v184, 16, v171
  v_and_b32 v185, 0xffff0000, v171
  v_pk_add_f32 v[196:197], v[196:197], v[184:185]
  v_lshlrev_b32 v186, 16, v175
  v_and_b32 v187, 0xffff0000, v175
  v_pk_add_f32 v[196:197], v[196:197], v[186:187]
  s_nop 1
  v_add_f32_dpp v190, v190, v190 row_ror:8 row_mask:0xf bank_mask:0xf
  v_add_f32_dpp v191, v191, v191 row_ror:8 row_mask:0xf bank_mask:0xf
  v_add_f32_dpp v192, v192, v192 row_ror:8 row_mask:0xf bank_mask:0xf
  v_add_f32_dpp v193, v193, v193 row_ror:8 row_mask:0xf bank_mask:0xf
  v_add_f32_dpp v194, v194, v194 row_ror:8 row_mask:0xf bank_mask:0xf
  v_add_f32_dpp v195, v195, v195 row_ror:8 row_mask:0xf bank_mask:0xf
  v_add_f32_dpp v196, v196, v196 row_ror:8 row_mask:0xf bank_mask:0xf
  v_add_f32_dpp v197, v197, v197 row_ror:8 row_mask:0xf bank_mask:0xf
  v_mov_b32 v200, v190
  v_mov_b32 v201, v191
  v_mov_b32 v202, v192
  v_mov_b32 v203, v193
  v_mov_b32 v204, v194
  v_mov_b32 v205, v195
  v_mov_b32 v206, v196
  v_mov_b32 v207, v197
  s_nop 1
  v_permlane16_swap_b32 v200, v190
  v_permlane16_swap_b32 v201, v191
  v_permlane16_swap_b32 v202, v192
  v_permlane16_swap_b32 v203, v193
  v_permlane16_swap_b32 v204, v194
  v_permlane16_swap_b32 v205, v195
  v_permlane16_swap_b32 v206, v196
  v_permlane16_swap_b32 v207, v197
  s_nop 1
  v_add_f32 v190, v190, v200
  v_add_f32 v191, v191, v201
  v_add_f32 v192, v192, v202
  v_add_f32 v193, v193, v203
  v_add_f32 v194, v194, v204
  v_add_f32 v195, v195, v205
  v_add_f32 v196, v196, v206
  v_add_f32 v197, v197, v207
  v_mov_b32 v200, v190
  v_mov_b32 v201, v191
  v_mov_b32 v202, v192
  v_mov_b32 v203, v193
  v_mov_b32 v204, v194
  v_mov_b32 v205, v195
  v_mov_b32 v206, v196
  v_mov_b32 v207, v197
  s_nop 1
  v_permlane32_swap_b32 v200, v190
  v_permlane32_swap_b32 v201, v191
  v_permlane32_swap_b32 v202, v192
  v_permlane32_swap_b32 v203, v193
  v_permlane32_swap_b32 v204, v194
  v_permlane32_swap_b32 v205, v195
  v_permlane32_swap_b32 v206, v196
  v_permlane32_swap_b32 v207, v197
  s_nop 1
  v_add_f32 v190, v190, v200
  v_add_f32 v191, v191, v201
  v_add_f32 v192, v192, v202
  v_add_f32 v193, v193, v203
  v_add_f32 v194, v194, v204
  v_add_f32 v195, v195, v205
  v_add_f32 v196, v196, v206
  v_add_f32 v197, v197, v207
  s_lshl_b32 s66, s49, 4
  s_add_u32 s66, s66, s48
  s_mul_i32 s66, s66, 768
  s_lshl_b32 s65, s70, 8
  s_add_u32 s66, s66, s65
  s_add_u32 s66, s66, 0x2200000
  v_lshlrev_b32 v10, 5, v1
  v_cmp_gt_u32 vcc, 8, v1
  s_and_saveexec_b64 s[90:91], vcc
  buffer_store_dwordx4 v[190:193], v10, s[8:11], s66 offen sc1
  buffer_store_dwordx4 v[194:197], v10, s[8:11], s66 offen offset:16 sc1
  s_mov_b64 exec, s[90:91]
L_nocs:
  s_waitcnt vmcnt(0)
  s_barrier
  s_cmp_eq_u32 s50, 4
  s_cbranch_scc0 interleave_layers__ssm_conv_h3__linear_attn_block__prompt_kernel_nm6
  v_cmp_eq_u32 vcc, 0, v1
  s_and_saveexec_b64 s[90:91], vcc
  v_mov_b32 v10, 1
  s_add_u32 s62, s59, 4096
  v_mov_b32 v11, s62
  buffer_atomic_add v10, v11, s[8:11], 0 offen sc1
  s_add_u32 s62, s58, 0
  v_mov_b32 v12, s62
  buffer_atomic_add v10, v12, s[8:11], 0 offen sc1
  s_add_u32 s62, s59, 4096
  s_add_u32 s63, s58, 0
  v_mov_b32 v5, s62
  v_mov_b32 v6, s63
  s_mov_b32 s61, 0
interleave_layers__ssm_conv_h3__linear_attn_block__prompt_kernel_pw7:
  buffer_load_dword v8, v5, s[8:11], 0 offen sc1
  buffer_load_dword v9, v6, s[8:11], 0 offen sc1
  s_add_u32 s61, s61, 1
  s_cmp_gt_u32 s61, 0x40000
  s_cbranch_scc1 interleave_layers__ssm_conv_h3__linear_attn_block__prompt_kernel_pwe8
  s_waitcnt vmcnt(0)
  v_xor_b32 v8, 16, v8
  v_xor_b32 v9, 16, v9
  v_or_b32 v8, v8, v9
  v_cmp_ne_u32 vcc, 0, v8
  s_cbranch_vccnz interleave_layers__ssm_conv_h3__linear_attn_block__prompt_kernel_pw7
interleave_layers__ssm_conv_h3__linear_attn_block__prompt_kernel_pwe8:
  s_mov_b64 exec, s[90:91]
interleave_layers__ssm_conv_h3__linear_attn_block__prompt_kernel_nm6:
  s_barrier
  v_lshrrev_b32 v5, 4, v1
  v_lshlrev_b32 v5, 12, v5
  v_and_b32 v6, 15, v1
  v_lshl_add_u32 v5, v6, 4, v5
  s_lshl_b32 s60, s49, 18
  s_lshl_b32 s61, s48, 8
  s_add_u32 s60, s60, s61
  s_lshl_b32 s61, s70, 16
  s_add_u32 s60, s60, s61
  s_add_u32 s60, s60, 0x400000
  s_lshl_b32 m0, s70, 12
  s_nop 0
  buffer_load_dwordx4 v5, s[8:11], s60 offen sc1 lds
  s_add_u32 s60, s60, 16384
  s_add_u32 m0, m0, 1024
  s_nop 0
  buffer_load_dwordx4 v5, s[8:11], s60 offen sc1 lds
  s_add_u32 s60, s60, 16384
  s_add_u32 m0, m0, 1024
  s_nop 0
  buffer_load_dwordx4 v5, s[8:11], s60 offen sc1 lds
  s_add_u32 s60, s60, 16384
  s_add_u32 m0, m0, 1024
  s_nop 0
  buffer_load_dwordx4 v5, s[8:11], s60 offen sc1 lds
  s_add_u32 s60, s60, 16384
  s_mul_i32 s77, s75, 393216
  s_add_u32 m0, s72, 0
  s_nop 0
  buffer_load_dwordx4 v216, s[28:31], s77 offen lds
  s_add_u32 m0, m0, 1024
  s_nop 0
  buffer_load_dwordx4 v217, s[28:31], s77 offen lds
  s_add_u32 m0, m0, 1024
  s_nop 0
  buffer_load_dwordx4 v218, s[28:31], s77 offen lds
  s_add_u32 m0, m0, 1024
  s_nop 0
  buffer_load_dwordx4 v219, s[28:31], s77 offen lds
  s_add_u32 m0, m0, 1024
  s_nop 0
  buffer_load_dwordx4 v220, s[28:31], s77 offen lds
  s_add_u32 m0, m0, 1024
  s_nop 0
  buffer_load_dwordx4 v221, s[28:31], s77 offen lds
  s_add_u32 s75, s75, 1
  s_and_b32 s75, s75, 15
  s_cmp_eq_u32 s50, 5
  s_cbranch_scc0 interleave_layers__ssm_conv_h3__linear_attn_block__prompt_kernel_zs9
  v_mov_b32 v5, 59392
  v_mov_b32 v8, 0
  v_mov_b32 v9, 0
  v_mov_b32 v10, 0
  v_mov_b32 v11, 0
  ds_write_b128 v5, v[8:11]
  s_waitcnt lgkmcnt(0)
interleave_layers__ssm_conv_h3__linear_attn_block__prompt_kernel_zs9:
  s_waitcnt vmcnt(6)
  s_barrier
L_hlayer:
  s_barrier
  s_add_u32 s80, s54, s79
  v_add_u32 v5, 81920, v24
  ds_read_b128 v[32:35], v5 offset:0
  ds_read_b128 v[36:39], v5 offset:1024
  ds_read_b128 v[40:43], v5 offset:2048
  ds_read_b128 v[44:47], v5 offset:3072
  s_waitcnt lgkmcnt(3)
  buffer_store_dwordx4 v[32:35], v16, s[8:11], s80 offen sc1
  s_waitcnt lgkmcnt(2)
  buffer_store_dwordx4 v[36:39], v17, s[8:11], s80 offen sc1
  s_waitcnt lgkmcnt(1)
  buffer_store_dwordx4 v[40:43], v18, s[8:11], s80 offen sc1
  s_waitcnt lgkmcnt(0)
  buffer_store_dwordx4 v[44:47], v19, s[8:11], s80 offen sc1
  s_cmp_ge_u32 s70, 2
  s_cbranch_scc1 interleave_layers__ssm_conv_h3__linear_attn_block__prompt_kernel_ss10
  s_lshl_b32 s60, s70, 9
  v_lshlrev_b32 v7, 3, v1
  v_add_u32 v6, s60, v7
  v_add_u32 v6, 57344, v6
  ds_read_b64 v[48:49], v6
  ds_read_b64 v[50:51], v6 offset:1024
  s_lshl_b32 s61, s48, 4
  s_add_u32 s61, s61, s49
  s_lshl_b32 s61, s61, 10
  s_add_u32 s60, s60, s61
  s_add_u32 s60, s60, s55
  s_waitcnt lgkmcnt(0)
  v_pk_add_f32 v[48:49], v[48:49], v[50:51]
  buffer_store_dwordx2 v[48:49], v7, s[8:11], s60 offen sc1
interleave_layers__ssm_conv_h3__linear_attn_block__prompt_kernel_ss10:
  s_mul_i32 s80, s53, 12288
  s_add_u32 s81, s80, 4096
  s_mov_b32 s78, s54
  s_add_u32 s74, s49, 1
  s_and_b32 s74, s74, 15
  s_waitcnt vmcnt(0)
  v_mov_b32 v5, 59392
  v_mov_b32 v6, 1
  v_cmp_eq_u32 vcc, 0, v1
  s_and_saveexec_b64 s[90:91], vcc
  ds_add_u32 v5, v6
  s_cmp_eq_u32 s50, 4
  s_cbranch_scc0 interleave_layers__ssm_conv_h3__linear_attn_block__prompt_kernel_lm11
  s_mov_b32 s61, 0
interleave_layers__ssm_conv_h3__linear_attn_block__prompt_kernel_l113:
  ds_read_b32 v7, v5
  s_add_u32 s61, s61, 1
  s_cmp_gt_u32 s61, 0x100000
  s_cbranch_scc1 interleave_layers__ssm_conv_h3__linear_attn_block__prompt_kernel_l1e14
  s_waitcnt lgkmcnt(0)
  v_cmp_ne_u32 vcc, 4, v7
  s_cbranch_vccnz interleave_layers__ssm_conv_h3__linear_attn_block__prompt_kernel_l113
interleave_layers__ssm_conv_h3__linear_attn_block__prompt_kernel_l1e14:
  s_add_u32 s62, s58, s81
  v_mov_b32 v11, s62
  buffer_atomic_add v6, v11, s[8:11], 0 offen sc1
  v_mov_b32 v5, s62
  s_mov_b32 s61, 0
interleave_layers__ssm_conv_h3__linear_attn_block__prompt_kernel_pw15:
  buffer_load_dword v8, v5, s[8:11], 0 offen sc1
  s_add_u32 s61, s61, 1
  s_cmp_gt_u32 s61, 0x40000
  s_cbranch_scc1 interleave_layers__ssm_conv_h3__linear_attn_block__prompt_kernel_pwe16
  s_waitcnt vmcnt(0)
  v_xor_b32 v8, 16, v8
  v_cmp_ne_u32 vcc, 0, v8
  s_cbranch_vccnz interleave_layers__ssm_conv_h3__linear_attn_block__prompt_kernel_pw15
interleave_layers__ssm_conv_h3__linear_attn_block__prompt_kernel_pwe16:
  v_mov_b32 v5, 59392
  v_mov_b32 v6, 1
  ds_write_b32 v5, v6 offset:4
  s_branch interleave_layers__ssm_conv_h3__linear_attn_block__prompt_kernel_ls12
interleave_layers__ssm_conv_h3__linear_attn_block__prompt_kernel_lm11:
  s_mov_b32 s61, 0
interleave_layers__ssm_conv_h3__linear_attn_block__prompt_kernel_l217:
  ds_read_b32 v7, v5 offset:4
  s_add_u32 s61, s61, 1
  s_cmp_gt_u32 s61, 0x400000
  s_cbranch_scc1 interleave_layers__ssm_conv_h3__linear_attn_block__prompt_kernel_ls12
  s_waitcnt lgkmcnt(0)
  v_cmp_ne_u32 vcc, 1, v7
  s_cbranch_vccnz interleave_layers__ssm_conv_h3__linear_attn_block__prompt_kernel_l217
interleave_layers__ssm_conv_h3__linear_attn_block__prompt_kernel_ls12:
  s_waitcnt lgkmcnt(0)
  s_mov_b64 exec, s[90:91]
  s_lshl_b32 s76, s74, 7
  s_add_u32 s76, s76, s78
  s_add_u32 m0, s71, 122880
  s_nop 0
  buffer_load_dwordx4 v16, s[8:11], s76 offen sc1 lds
  s_add_u32 m0, m0, 1024
  s_nop 0
  buffer_load_dwordx4 v17, s[8:11], s76 offen sc1 lds
  s_add_u32 m0, m0, 1024
  s_nop 0
  buffer_load_dwordx4 v18, s[8:11], s76 offen sc1 lds
  s_add_u32 m0, m0, 1024
  s_nop 0
  buffer_load_dwordx4 v19, s[8:11], s76 offen sc1 lds
  s_add_u32 s74, s74, 1
  s_and_b32 s74, s74, 15
  s_lshl_b32 s76, s74, 7
  s_add_u32 s76, s76, s78
  s_add_u32 m0, s71, 0
  s_nop 0
  buffer_load_dwordx4 v16, s[8:11], s76 offen sc1 lds
  s_add_u32 m0, m0, 1024
  s_nop 0
  buffer_load_dwordx4 v17, s[8:11], s76 offen sc1 lds
  s_add_u32 m0, m0, 1024
  s_nop 0
  buffer_load_dwordx4 v18, s[8:11], s76 offen sc1 lds
  s_add_u32 m0, m0, 1024
  s_nop 0
  buffer_load_dwordx4 v19, s[8:11], s76 offen sc1 lds
  s_add_u32 s74, s74, 1
  s_and_b32 s74, s74, 15
  s_waitcnt vmcnt(4)
  s_barrier
  s_lshl_b32 s76, s74, 7
  s_add_u32 s76, s76, s78
  s_add_u32 m0, s71, 40960
  s_nop 0
  buffer_load_dwordx4 v16, s[8:11], s76 offen sc1 lds
  s_add_u32 m0, m0, 1024
  s_nop 0
  buffer_load_dwordx4 v17, s[8:11], s76 offen sc1 lds
  s_add_u32 m0, m0, 1024
  s_nop 0
  buffer_load_dwordx4 v18, s[8:11], s76 offen sc1 lds
  s_add_u32 m0, m0, 1024
  s_nop 0
  buffer_load_dwordx4 v19, s[8:11], s76 offen sc1 lds
  s_add_u32 s74, s74, 1
  s_and_b32 s74, s74, 15
  s_mul_i32 s77, s75, 393216
  s_add_u32 m0, s72, 40960
  s_nop 0
  buffer_load_dwordx4 v216, s[28:31], s77 offen lds
  s_add_u32 m0, m0, 1024
  s_nop 0
  buffer_load_dwordx4 v217, s[28:31], s77 offen lds
  s_add_u32 m0, m0, 1024
  s_nop 0
  buffer_load_dwordx4 v218, s[28:31], s77 offen lds
  s_add_u32 m0, m0, 1024
  s_nop 0
  buffer_load_dwordx4 v219, s[28:31], s77 offen lds
  s_add_u32 m0, m0, 1024
  s_nop 0
  buffer_load_dwordx4 v220, s[28:31], s77 offen lds
  s_add_u32 m0, m0, 1024
  s_nop 0
  buffer_load_dwordx4 v221, s[28:31], s77 offen lds
  s_add_u32 s75, s75, 1
  s_and_b32 s75, s75, 15
  s_waitcnt vmcnt(10)
  s_barrier
  s_lshl_b32 s76, s74, 7
  s_add_u32 s76, s76, s78
  s_add_u32 m0, s71, 81920
  s_nop 0
  buffer_load_dwordx4 v16, s[8:11], s76 offen sc1 lds
  s_add_u32 m0, m0, 1024
  s_nop 0
  buffer_load_dwordx4 v17, s[8:11], s76 offen sc1 lds
  s_add_u32 m0, m0, 1024
  s_nop 0
  buffer_load_dwordx4 v18, s[8:11], s76 offen sc1 lds
  s_add_u32 m0, m0, 1024
  s_nop 0
  buffer_load_dwordx4 v19, s[8:11], s76 offen sc1 lds
  s_add_u32 s74, s74, 1
  s_and_b32 s74, s74, 15
  s_mul_i32 s77, s75, 393216
  s_add_u32 m0, s72, 81920
  s_nop 0
  buffer_load_dwordx4 v216, s[28:31], s77 offen lds
  s_add_u32 m0, m0, 1024
  s_nop 0
  buffer_load_dwordx4 v217, s[28:31], s77 offen lds
  s_add_u32 m0, m0, 1024
  s_nop 0
  buffer_load_dwordx4 v218, s[28:31], s77 offen lds
  s_add_u32 m0, m0, 1024
  s_nop 0
  buffer_load_dwordx4 v219, s[28:31], s77 offen lds
  s_add_u32 m0, m0, 1024
  s_nop 0
  buffer_load_dwordx4 v220, s[28:31], s77 offen lds
  s_add_u32 m0, m0, 1024
  s_nop 0
  buffer_load_dwordx4 v221, s[28:31], s77 offen lds
  s_add_u32 s75, s75, 1
  s_and_b32 s75, s75, 15
  s_waitcnt vmcnt(10)
  s_barrier
  s_lshl_b32 s76, s74, 7
  s_add_u32 s76, s76, s78
  s_add_u32 m0, s71, 122880
  s_nop 0
  buffer_load_dwordx4 v16, s[8:11], s76 offen sc1 lds
  s_add_u32 m0, m0, 1024
  s_nop 0
  buffer_load_dwordx4 v17, s[8:11], s76 offen sc1 lds
  s_add_u32 m0, m0, 1024
  s_nop 0
  buffer_load_dwordx4 v18, s[8:11], s76 offen sc1 lds
  s_add_u32 m0, m0, 1024
  s_nop 0
  buffer_load_dwordx4 v19, s[8:11], s76 offen sc1 lds
  s_add_u32 s74, s74, 1
  s_and_b32 s74, s74, 15
  s_mul_i32 s77, s75, 393216
  s_add_u32 m0, s72, 122880
  s_nop 0
  buffer_load_dwordx4 v216, s[28:31], s77 offen lds
  s_add_u32 m0, m0, 1024
  s_nop 0
  buffer_load_dwordx4 v217, s[28:31], s77 offen lds
  s_add_u32 m0, m0, 1024
  s_nop 0
  buffer_load_dwordx4 v218, s[28:31], s77 offen lds
  s_add_u32 m0, m0, 1024
  s_nop 0
  buffer_load_dwordx4 v219, s[28:31], s77 offen lds
  s_add_u32 m0, m0, 1024
  s_nop 0
  buffer_load_dwordx4 v220, s[28:31], s77 offen lds
  s_add_u32 m0, m0, 1024
  s_nop 0
  buffer_load_dwordx4 v221, s[28:31], s77 offen lds
  s_add_u32 s75, s75, 1
  s_and_b32 s75, s75, 15
  s_waitcnt vmcnt(10)
  s_barrier
  s_lshl_b32 s76, s74, 7
  s_add_u32 s76, s76, s78
  s_add_u32 m0, s71, 0
  s_nop 0
  buffer_load_dwordx4 v16, s[8:11], s76 offen sc1 lds
  s_add_u32 m0, m0, 1024
  s_nop 0
  buffer_load_dwordx4 v17, s[8:11], s76 offen sc1 lds
  s_add_u32 m0, m0, 1024
  s_nop 0
  buffer_load_dwordx4 v18, s[8:11], s76 offen sc1 lds
  s_add_u32 m0, m0, 1024
  s_nop 0
  buffer_load_dwordx4 v19, s[8:11], s76 offen sc1 lds
  s_add_u32 s74, s74, 1
  s_and_b32 s74, s74, 15
  s_mul_i32 s77, s75, 393216
  s_add_u32 m0, s72, 0
  s_nop 0
  buffer_load_dwordx4 v216, s[28:31], s77 offen lds
  s_add_u32 m0, m0, 1024
  s_nop 0
  buffer_load_dwordx4 v217, s[28:31], s77 offen lds
  s_add_u32 m0, m0, 1024
  s_nop 0
  buffer_load_dwordx4 v218, s[28:31], s77 offen lds
  s_add_u32 m0, m0, 1024
  s_nop 0
  buffer_load_dwordx4 v219, s[28:31], s77 offen lds
  s_add_u32 m0, m0, 1024
  s_nop 0
  buffer_load_dwordx4 v220, s[28:31], s77 offen lds
  s_add_u32 m0, m0, 1024
  s_nop 0
  buffer_load_dwordx4 v221, s[28:31], s77 offen lds
  s_add_u32 s75, s75, 1
  s_and_b32 s75, s75, 15
  s_waitcnt vmcnt(10)
  s_barrier
  s_lshl_b32 s76, s74, 7
  s_add_u32 s76, s76, s78
  s_add_u32 m0, s71, 40960
  s_nop 0
  buffer_load_dwordx4 v16, s[8:11], s76 offen sc1 lds
  s_add_u32 m0, m0, 1024
  s_nop 0
  buffer_load_dwordx4 v17, s[8:11], s76 offen sc1 lds
  s_add_u32 m0, m0, 1024
  s_nop 0
  buffer_load_dwordx4 v18, s[8:11], s76 offen sc1 lds
  s_add_u32 m0, m0, 1024
  s_nop 0
  buffer_load_dwordx4 v19, s[8:11], s76 offen sc1 lds
  s_add_u32 s74, s74, 1
  s_and_b32 s74, s74, 15
  s_mul_i32 s77, s75, 393216
  s_add_u32 m0, s72, 40960
  s_nop 0
  buffer_load_dwordx4 v216, s[28:31], s77 offen lds
  s_add_u32 m0, m0, 1024
  s_nop 0
  buffer_load_dwordx4 v217, s[28:31], s77 offen lds
  s_add_u32 m0, m0, 1024
  s_nop 0
  buffer_load_dwordx4 v218, s[28:31], s77 offen lds
  s_add_u32 m0, m0, 1024
  s_nop 0
  buffer_load_dwordx4 v219, s[28:31], s77 offen lds
  s_add_u32 m0, m0, 1024
  s_nop 0
  buffer_load_dwordx4 v220, s[28:31], s77 offen lds
  s_add_u32 m0, m0, 1024
  s_nop 0
  buffer_load_dwordx4 v221, s[28:31], s77 offen lds
  s_add_u32 s75, s75, 1
  s_and_b32 s75, s75, 15
  s_waitcnt vmcnt(10)
  s_barrier
  s_lshl_b32 s76, s74, 7
  s_add_u32 s76, s76, s78
  s_add_u32 m0, s71, 81920
  s_nop 0
  buffer_load_dwordx4 v16, s[8:11], s76 offen sc1 lds
  s_add_u32 m0, m0, 1024
  s_nop 0
  buffer_load_dwordx4 v17, s[8:11], s76 offen sc1 lds
  s_add_u32 m0, m0, 1024
  s_nop 0
  buffer_load_dwordx4 v18, s[8:11], s76 offen sc1 lds
  s_add_u32 m0, m0, 1024
  s_nop 0
  buffer_load_dwordx4 v19, s[8:11], s76 offen sc1 lds
  s_add_u32 s74, s74, 1
  s_and_b32 s74, s74, 15
  s_mul_i32 s77, s75, 393216
  s_add_u32 m0, s72, 81920
  s_nop 0
  buffer_load_dwordx4 v216, s[28:31], s77 offen lds
  s_add_u32 m0, m0, 1024
  s_nop 0
  buffer_load_dwordx4 v217, s[28:31], s77 offen lds
  s_add_u32 m0, m0, 1024
  s_nop 0
  buffer_load_dwordx4 v218, s[28:31], s77 offen lds
  s_add_u32 m0, m0, 1024
  s_nop 0
  buffer_load_dwordx4 v219, s[28:31], s77 offen lds
  s_add_u32 m0, m0, 1024
  s_nop 0
  buffer_load_dwordx4 v220, s[28:31], s77 offen lds
  s_add_u32 m0, m0, 1024
  s_nop 0
  buffer_load_dwordx4 v221, s[28:31], s77 offen lds
  s_add_u32 s75, s75, 1
  s_and_b32 s75, s75, 15
  s_waitcnt vmcnt(10)
  s_barrier
  s_lshl_b32 s76, s74, 7
  s_add_u32 s76, s76, s78
  s_add_u32 m0, s71, 122880
  s_nop 0
  buffer_load_dwordx4 v16, s[8:11], s76 offen sc1 lds
  s_add_u32 m0, m0, 1024
  s_nop 0
  buffer_load_dwordx4 v17, s[8:11], s76 offen sc1 lds
  s_add_u32 m0, m0, 1024
  s_nop 0
  buffer_load_dwordx4 v18, s[8:11], s76 offen sc1 lds
  s_add_u32 m0, m0, 1024
  s_nop 0
  buffer_load_dwordx4 v19, s[8:11], s76 offen sc1 lds
  s_add_u32 s74, s74, 1
  s_and_b32 s74, s74, 15
  s_mul_i32 s77, s75, 393216
  s_add_u32 m0, s72, 122880
  s_nop 0
  buffer_load_dwordx4 v216, s[28:31], s77 offen lds
  s_add_u32 m0, m0, 1024
  s_nop 0
  buffer_load_dwordx4 v217, s[28:31], s77 offen lds
  s_add_u32 m0, m0, 1024
  s_nop 0
  buffer_load_dwordx4 v218, s[28:31], s77 offen lds
  s_add_u32 m0, m0, 1024
  s_nop 0
  buffer_load_dwordx4 v219, s[28:31], s77 offen lds
  s_add_u32 m0, m0, 1024
  s_nop 0
  buffer_load_dwordx4 v220, s[28:31], s77 offen lds
  s_add_u32 m0, m0, 1024
  s_nop 0
  buffer_load_dwordx4 v221, s[28:31], s77 offen lds
  s_add_u32 s75, s75, 1
  s_and_b32 s75, s75, 15
  s_waitcnt vmcnt(10)
  s_barrier
  s_lshl_b32 s76, s74, 7
  s_add_u32 s76, s76, s78
  s_add_u32 m0, s71, 0
  s_nop 0
  buffer_load_dwordx4 v16, s[8:11], s76 offen sc1 lds
  s_add_u32 m0, m0, 1024
  s_nop 0
  buffer_load_dwordx4 v17, s[8:11], s76 offen sc1 lds
  s_add_u32 m0, m0, 1024
  s_nop 0
  buffer_load_dwordx4 v18, s[8:11], s76 offen sc1 lds
  s_add_u32 m0, m0, 1024
  s_nop 0
  buffer_load_dwordx4 v19, s[8:11], s76 offen sc1 lds
  s_add_u32 s74, s74, 1
  s_and_b32 s74, s74, 15
  s_mul_i32 s77, s75, 393216
  s_add_u32 m0, s72, 0
  s_nop 0
  buffer_load_dwordx4 v216, s[28:31], s77 offen lds
  s_add_u32 m0, m0, 1024
  s_nop 0
  buffer_load_dwordx4 v217, s[28:31], s77 offen lds
  s_add_u32 m0, m0, 1024
  s_nop 0
  buffer_load_dwordx4 v218, s[28:31], s77 offen lds
  s_add_u32 m0, m0, 1024
  s_nop 0
  buffer_load_dwordx4 v219, s[28:31], s77 offen lds
  s_add_u32 m0, m0, 1024
  s_nop 0
  buffer_load_dwordx4 v220, s[28:31], s77 offen lds
  s_add_u32 m0, m0, 1024
  s_nop 0
  buffer_load_dwordx4 v221, s[28:31], s77 offen lds
  s_add_u32 s75, s75, 1
  s_and_b32 s75, s75, 15
  s_waitcnt vmcnt(10)
  s_barrier
  s_lshl_b32 s76, s74, 7
  s_add_u32 s76, s76, s78
  s_add_u32 m0, s71, 40960
  s_nop 0
  buffer_load_dwordx4 v16, s[8:11], s76 offen sc1 lds
  s_add_u32 m0, m0, 1024
  s_nop 0
  buffer_load_dwordx4 v17, s[8:11], s76 offen sc1 lds
  s_add_u32 m0, m0, 1024
  s_nop 0
  buffer_load_dwordx4 v18, s[8:11], s76 offen sc1 lds
  s_add_u32 m0, m0, 1024
  s_nop 0
  buffer_load_dwordx4 v19, s[8:11], s76 offen sc1 lds
  s_add_u32 s74, s74, 1
  s_and_b32 s74, s74, 15
  s_mul_i32 s77, s75, 393216
  s_add_u32 m0, s72, 40960
  s_nop 0
  buffer_load_dwordx4 v216, s[28:31], s77 offen lds
  s_add_u32 m0, m0, 1024
  s_nop 0
  buffer_load_dwordx4 v217, s[28:31], s77 offen lds
  s_add_u32 m0, m0, 1024
  s_nop 0
  buffer_load_dwordx4 v218, s[28:31], s77 offen lds
  s_add_u32 m0, m0, 1024
  s_nop 0
  buffer_load_dwordx4 v219, s[28:31], s77 offen lds
  s_add_u32 m0, m0, 1024
  s_nop 0
  buffer_load_dwordx4 v220, s[28:31], s77 offen lds
  s_add_u32 m0, m0, 1024
  s_nop 0
  buffer_load_dwordx4 v221, s[28:31], s77 offen lds
  s_add_u32 s75, s75, 1
  s_and_b32 s75, s75, 15
  s_waitcnt vmcnt(10)
  s_barrier
  s_lshl_b32 s76, s74, 7
  s_add_u32 s76, s76, s78
  s_add_u32 m0, s71, 81920
  s_nop 0
  buffer_load_dwordx4 v16, s[8:11], s76 offen sc1 lds
  s_add_u32 m0, m0, 1024
  s_nop 0
  buffer_load_dwordx4 v17, s[8:11], s76 offen sc1 lds
  s_add_u32 m0, m0, 1024
  s_nop 0
  buffer_load_dwordx4 v18, s[8:11], s76 offen sc1 lds
  s_add_u32 m0, m0, 1024
  s_nop 0
  buffer_load_dwordx4 v19, s[8:11], s76 offen sc1 lds
  s_add_u32 s74, s74, 1
  s_and_b32 s74, s74, 15
  s_mul_i32 s77, s75, 393216
  s_add_u32 m0, s72, 81920
  s_nop 0
  buffer_load_dwordx4 v216, s[28:31], s77 offen lds
  s_add_u32 m0, m0, 1024
  s_nop 0
  buffer_load_dwordx4 v217, s[28:31], s77 offen lds
  s_add_u32 m0, m0, 1024
  s_nop 0
  buffer_load_dwordx4 v218, s[28:31], s77 offen lds
  s_add_u32 m0, m0, 1024
  s_nop 0
  buffer_load_dwordx4 v219, s[28:31], s77 offen lds
  s_add_u32 m0, m0, 1024
  s_nop 0
  buffer_load_dwordx4 v220, s[28:31], s77 offen lds
  s_add_u32 m0, m0, 1024
  s_nop 0
  buffer_load_dwordx4 v221, s[28:31], s77 offen lds
  s_add_u32 s75, s75, 1
  s_and_b32 s75, s75, 15
  s_waitcnt vmcnt(10)
  s_barrier
  s_lshl_b32 s76, s74, 7
  s_add_u32 s76, s76, s78
  s_add_u32 m0, s71, 122880
  s_nop 0
  buffer_load_dwordx4 v16, s[8:11], s76 offen sc1 lds
  s_add_u32 m0, m0, 1024
  s_nop 0
  buffer_load_dwordx4 v17, s[8:11], s76 offen sc1 lds
  s_add_u32 m0, m0, 1024
  s_nop 0
  buffer_load_dwordx4 v18, s[8:11], s76 offen sc1 lds
  s_add_u32 m0, m0, 1024
  s_nop 0
  buffer_load_dwordx4 v19, s[8:11], s76 offen sc1 lds
  s_add_u32 s74, s74, 1
  s_and_b32 s74, s74, 15
  s_mul_i32 s77, s75, 393216
  s_add_u32 m0, s72, 122880
  s_nop 0
  buffer_load_dwordx4 v216, s[28:31], s77 offen lds
  s_add_u32 m0, m0, 1024
  s_nop 0
  buffer_load_dwordx4 v217, s[28:31], s77 offen lds
  s_add_u32 m0, m0, 1024
  s_nop 0
  buffer_load_dwordx4 v218, s[28:31], s77 offen lds
  s_add_u32 m0, m0, 1024
  s_nop 0
  buffer_load_dwordx4 v219, s[28:31], s77 offen lds
  s_add_u32 m0, m0, 1024
  s_nop 0
  buffer_load_dwordx4 v220, s[28:31], s77 offen lds
  s_add_u32 m0, m0, 1024
  s_nop 0
  buffer_load_dwordx4 v221, s[28:31], s77 offen lds
  s_add_u32 s75, s75, 1
  s_and_b32 s75, s75, 15
  s_waitcnt vmcnt(10)
  s_barrier
  s_lshl_b32 s76, s74, 7
  s_add_u32 s76, s76, s78
  s_add_u32 m0, s71, 0
  s_nop 0
  buffer_load_dwordx4 v16, s[8:11], s76 offen sc1 lds
  s_add_u32 m0, m0, 1024
  s_nop 0
  buffer_load_dwordx4 v17, s[8:11], s76 offen sc1 lds
  s_add_u32 m0, m0, 1024
  s_nop 0
  buffer_load_dwordx4 v18, s[8:11], s76 offen sc1 lds
  s_add_u32 m0, m0, 1024
  s_nop 0
  buffer_load_dwordx4 v19, s[8:11], s76 offen sc1 lds
  s_add_u32 s74, s74, 1
  s_and_b32 s74, s74, 15
  s_mul_i32 s77, s75, 393216
  s_add_u32 m0, s72, 0
  s_nop 0
  buffer_load_dwordx4 v216, s[28:31], s77 offen lds
  s_add_u32 m0, m0, 1024
  s_nop 0
  buffer_load_dwordx4 v217, s[28:31], s77 offen lds
  s_add_u32 m0, m0, 1024
  s_nop 0
  buffer_load_dwordx4 v218, s[28:31], s77 offen lds
  s_add_u32 m0, m0, 1024
  s_nop 0
  buffer_load_dwordx4 v219, s[28:31], s77 offen lds
  s_add_u32 m0, m0, 1024
  s_nop 0
  buffer_load_dwordx4 v220, s[28:31], s77 offen lds
  s_add_u32 m0, m0, 1024
  s_nop 0
  buffer_load_dwordx4 v221, s[28:31], s77 offen lds
  s_add_u32 s75, s75, 1
  s_and_b32 s75, s75, 15
  s_waitcnt vmcnt(10)
  s_barrier
  s_lshl_b32 s76, s74, 7
  s_add_u32 s76, s76, s78
  s_add_u32 m0, s71, 40960
  s_nop 0
  buffer_load_dwordx4 v16, s[8:11], s76 offen sc1 lds
  s_add_u32 m0, m0, 1024
  s_nop 0
  buffer_load_dwordx4 v17, s[8:11], s76 offen sc1 lds
  s_add_u32 m0, m0, 1024
  s_nop 0
  buffer_load_dwordx4 v18, s[8:11], s76 offen sc1 lds
  s_add_u32 m0, m0, 1024
  s_nop 0
  buffer_load_dwordx4 v19, s[8:11], s76 offen sc1 lds
  s_add_u32 s74, s74, 1
  s_and_b32 s74, s74, 15
  s_mul_i32 s77, s75, 393216
  s_add_u32 m0, s72, 40960
  s_nop 0
  buffer_load_dwordx4 v216, s[28:31], s77 offen lds
  s_add_u32 m0, m0, 1024
  s_nop 0
  buffer_load_dwordx4 v217, s[28:31], s77 offen lds
  s_add_u32 m0, m0, 1024
  s_nop 0
  buffer_load_dwordx4 v218, s[28:31], s77 offen lds
  s_add_u32 m0, m0, 1024
  s_nop 0
  buffer_load_dwordx4 v219, s[28:31], s77 offen lds
  s_add_u32 m0, m0, 1024
  s_nop 0
  buffer_load_dwordx4 v220, s[28:31], s77 offen lds
  s_add_u32 m0, m0, 1024
  s_nop 0
  buffer_load_dwordx4 v221, s[28:31], s77 offen lds
  s_add_u32 s75, s75, 1
  s_and_b32 s75, s75, 15
  s_waitcnt vmcnt(10)
  s_barrier
  s_waitcnt vmcnt(0)
  s_barrier
  s_barrier
  s_barrier
  s_add_u32 s81, s53, 2
  s_mul_i32 s81, s81, 4096
  s_cmp_eq_u32 s50, 4
  s_cbranch_scc0 interleave_layers__ssm_conv_h3__linear_attn_block__prompt_kernel_nm18
  v_cmp_eq_u32 vcc, 0, v1
  s_and_saveexec_b64 s[90:91], vcc
  v_mov_b32 v10, 1
  s_add_u32 s62, s59, s81
  v_mov_b32 v11, s62
  buffer_atomic_add v10, v11, s[8:11], 0 offen sc1
  s_add_u32 s62, s59, s81
  v_mov_b32 v5, s62
  s_mov_b32 s61, 0
interleave_layers__ssm_conv_h3__linear_attn_block__prompt_kernel_pw19:
  buffer_load_dword v8, v5, s[8:11], 0 offen sc1
  s_add_u32 s61, s61, 1
  s_cmp_gt_u32 s61, 0x40000
  s_cbranch_scc1 interleave_layers__ssm_conv_h3__linear_attn_block__prompt_kernel_pwe20
  s_waitcnt vmcnt(0)
  v_xor_b32 v8, 16, v8
  v_cmp_ne_u32 vcc, 0, v8
  s_cbranch_vccnz interleave_layers__ssm_conv_h3__linear_attn_block__prompt_kernel_pw19
interleave_layers__ssm_conv_h3__linear_attn_block__prompt_kernel_pwe20:
  s_mov_b64 exec, s[90:91]
interleave_layers__ssm_conv_h3__linear_attn_block__prompt_kernel_nm18:
  s_barrier
  s_lshl_b32 s60, s49, 1
  s_add_u32 s60, s60, s52
  s_lshl_b32 s60, s60, 4
  s_lshr_b32 s61, s50, 2
  s_lshl_b32 s61, s61, 1
  s_add_u32 s61, s61, s51
  s_lshl_b32 s61, s61, 2
  s_add_u32 s60, s60, s61
  s_mul_i32 s60, s60, 2304
  s_add_u32 s60, s60, s56
  v_lshlrev_b32 v6, 4, v1
  v_lshlrev_b32 v7, 2, v2
  v_add_u32 v7, 2048, v7
  buffer_load_dwordx4 v[128:131], v6, s[8:11], s60 offen offset:0 sc1
  buffer_load_dwordx4 v[132:135], v6, s[8:11], s60 offen offset:1024 sc1
  buffer_load_dword v48, v7, s[8:11], s60 offen sc1
  s_add_u32 s60, s60, 2304
  buffer_load_dwordx4 v[136:139], v6, s[8:11], s60 offen offset:0 sc1
  buffer_load_dwordx4 v[140:143], v6, s[8:11], s60 offen offset:1024 sc1
  buffer_load_dword v49, v7, s[8:11], s60 offen sc1
  s_add_u32 s60, s60, 2304
  buffer_load_dwordx4 v[144:147], v6, s[8:11], s60 offen offset:0 sc1
  buffer_load_dwordx4 v[148:151], v6, s[8:11], s60 offen offset:1024 sc1
  buffer_load_dword v50, v7, s[8:11], s60 offen sc1
  s_add_u32 s60, s60, 2304
  buffer_load_dwordx4 v[152:155], v6, s[8:11], s60 offen offset:0 sc1
  buffer_load_dwordx4 v[156:159], v6, s[8:11], s60 offen offset:1024 sc1
  buffer_load_dword v51, v7, s[8:11], s60 offen sc1
  s_lshr_b32 s63, s50, 1
  s_add_u32 s63, s63, 1
  s_mul_i32 s63, s63, 24576
  s_lshl_b32 s64, s51, 13
  s_add_u32 s63, s63, s64
  v_add_u32 v13, s63, v6
  v_lshlrev_b32 v14, 2, v1
  v_add_u32 v14, s63, v14
  s_waitcnt vmcnt(9)
  v_lshlrev_b32 v32, 16, v128
  v_and_b32 v33, 0xffff0000, v128
  v_lshlrev_b32 v34, 16, v129
  v_and_b32 v35, 0xffff0000, v129
  v_lshlrev_b32 v36, 16, v130
  v_and_b32 v37, 0xffff0000, v130
  v_lshlrev_b32 v38, 16, v131
  v_and_b32 v39, 0xffff0000, v131
  v_lshlrev_b32 v40, 16, v132
  v_and_b32 v41, 0xffff0000, v132
  v_lshlrev_b32 v42, 16, v133
  v_and_b32 v43, 0xffff0000, v133
  v_lshlrev_b32 v44, 16, v134
  v_and_b32 v45, 0xffff0000, v134
  v_lshlrev_b32 v46, 16, v135
  v_and_b32 v47, 0xffff0000, v135
  s_waitcnt vmcnt(6)
  v_lshlrev_b32 v52, 16, v136
  v_and_b32 v53, 0xffff0000, v136
  v_pk_add_f32 v[32:33], v[32:33], v[52:53]
  v_lshlrev_b32 v54, 16, v137
  v_and_b32 v55, 0xffff0000, v137
  v_pk_add_f32 v[34:35], v[34:35], v[54:55]
  v_lshlrev_b32 v52, 16, v138
  v_and_b32 v53, 0xffff0000, v138
  v_pk_add_f32 v[36:37], v[36:37], v[52:53]
  v_lshlrev_b32 v54, 16, v139
  v_and_b32 v55, 0xffff0000, v139
  v_pk_add_f32 v[38:39], v[38:39], v[54:55]
  v_lshlrev_b32 v52, 16, v140
  v_and_b32 v53, 0xffff0000, v140
  v_pk_add_f32 v[40:41], v[40:41], v[52:53]
  v_lshlrev_b32 v54, 16, v141
  v_and_b32 v55, 0xffff0000, v141
  v_pk_add_f32 v[42:43], v[42:43], v[54:55]
  v_lshlrev_b32 v52, 16, v142
  v_and_b32 v53, 0xffff0000, v142
  v_pk_add_f32 v[44:45], v[44:45], v[52:53]
  v_lshlrev_b32 v54, 16, v143
  v_and_b32 v55, 0xffff0000, v143
  v_pk_add_f32 v[46:47], v[46:47], v[54:55]
  s_waitcnt vmcnt(3)
  v_lshlrev_b32 v52, 16, v144
  v_and_b32 v53, 0xffff0000, v144
  v_pk_add_f32 v[32:33], v[32:33], v[52:53]
  v_lshlrev_b32 v54, 16, v145
  v_and_b32 v55, 0xffff0000, v145
  v_pk_add_f32 v[34:35], v[34:35], v[54:55]
  v_lshlrev_b32 v52, 16, v146
  v_and_b32 v53, 0xffff0000, v146
  v_pk_add_f32 v[36:37], v[36:37], v[52:53]
  v_lshlrev_b32 v54, 16, v147
  v_and_b32 v55, 0xffff0000, v147
  v_pk_add_f32 v[38:39], v[38:39], v[54:55]
  v_lshlrev_b32 v52, 16, v148
  v_and_b32 v53, 0xffff0000, v148
  v_pk_add_f32 v[40:41], v[40:41], v[52:53]
  v_lshlrev_b32 v54, 16, v149
  v_and_b32 v55, 0xffff0000, v149
  v_pk_add_f32 v[42:43], v[42:43], v[54:55]
  v_lshlrev_b32 v52, 16, v150
  v_and_b32 v53, 0xffff0000, v150
  v_pk_add_f32 v[44:45], v[44:45], v[52:53]
  v_lshlrev_b32 v54, 16, v151
  v_and_b32 v55, 0xffff0000, v151
  v_pk_add_f32 v[46:47], v[46:47], v[54:55]
  s_waitcnt vmcnt(0)
  v_lshlrev_b32 v52, 16, v152
  v_and_b32 v53, 0xffff0000, v152
  v_pk_add_f32 v[32:33], v[32:33], v[52:53]
  v_lshlrev_b32 v54, 16, v153
  v_and_b32 v55, 0xffff0000, v153
  v_pk_add_f32 v[34:35], v[34:35], v[54:55]
  v_lshlrev_b32 v52, 16, v154
  v_and_b32 v53, 0xffff0000, v154
  v_pk_add_f32 v[36:37], v[36:37], v[52:53]
  v_lshlrev_b32 v54, 16, v155
  v_and_b32 v55, 0xffff0000, v155
  v_pk_add_f32 v[38:39], v[38:39], v[54:55]
  v_lshlrev_b32 v52, 16, v156
  v_and_b32 v53, 0xffff0000, v156
  v_pk_add_f32 v[40:41], v[40:41], v[52:53]
  v_lshlrev_b32 v54, 16, v157
  v_and_b32 v55, 0xffff0000, v157
  v_pk_add_f32 v[42:43], v[42:43], v[54:55]
  v_lshlrev_b32 v52, 16, v158
  v_and_b32 v53, 0xffff0000, v158
  v_pk_add_f32 v[44:45], v[44:45], v[52:53]
  v_lshlrev_b32 v54, 16, v159
  v_and_b32 v55, 0xffff0000, v159
  v_pk_add_f32 v[46:47], v[46:47], v[54:55]
  v_add_f32 v48, v48, v49
  v_add_f32 v48, v48, v50
  v_add_f32 v48, v48, v51
  ds_write_b128 v13, v[32:35] offset:0
  ds_write_b128 v13, v[36:39] offset:1024
  ds_write_b128 v13, v[40:43] offset:2048
  ds_write_b128 v13, v[44:47] offset:3072
  ds_write_b32 v14, v48 offset:4096
  s_waitcnt lgkmcnt(0)
  s_mov_b32 s75, s49
  s_lshl_b32 s77, s75, 17
  s_add_u32 m0, s73, 0
  s_nop 0
  buffer_load_dwordx4 v20, s[32:35], s77 offen lds
  s_add_u32 m0, m0, 1024
  s_nop 0
  buffer_load_dwordx4 v21, s[32:35], s77 offen lds
  s_add_u32 s75, s75, 1
  s_and_b32 s75, s75, 15
  s_lshl_b32 s77, s75, 17
  s_add_u32 m0, s73, 24576
  s_nop 0
  buffer_load_dwordx4 v20, s[32:35], s77 offen lds
  s_add_u32 m0, m0, 1024
  s_nop 0
  buffer_load_dwordx4 v21, s[32:35], s77 offen lds
  s_add_u32 s75, s75, 1
  s_and_b32 s75, s75, 15
  s_lshl_b32 s77, s75, 17
  s_add_u32 m0, s73, 49152
  s_nop 0
  buffer_load_dwordx4 v20, s[32:35], s77 offen lds
  s_add_u32 m0, m0, 1024
  s_nop 0
  buffer_load_dwordx4 v21, s[32:35], s77 offen lds
  s_add_u32 s75, s75, 1
  s_and_b32 s75, s75, 15
  s_lshl_b32 s77, s75, 17
  s_add_u32 m0, s73, 73728
  s_nop 0
  buffer_load_dwordx4 v20, s[32:35], s77 offen lds
  s_add_u32 m0, m0, 1024
  s_nop 0
  buffer_load_dwordx4 v21, s[32:35], s77 offen lds
  s_add_u32 s75, s75, 1
  s_and_b32 s75, s75, 15
  s_lshl_b32 s77, s75, 17
  s_add_u32 m0, s73, 98304
  s_nop 0
  buffer_load_dwordx4 v20, s[32:35], s77 offen lds
  s_add_u32 m0, m0, 1024
  s_nop 0
  buffer_load_dwordx4 v21, s[32:35], s77 offen lds
  s_add_u32 s75, s75, 1
  s_and_b32 s75, s75, 15
  s_cmp_eq_u32 s50, 5
  s_cbranch_scc0 interleave_layers__ssm_conv_h3__linear_attn_block__prompt_kernel_zs21
  v_mov_b32 v5, 147456
  v_mov_b32 v8, 0
  v_mov_b32 v9, 0
  v_mov_b32 v10, 0
  v_mov_b32 v11, 0
  ds_write_b128 v5, v[8:11]
  s_waitcnt lgkmcnt(0)
interleave_layers__ssm_conv_h3__linear_attn_block__prompt_kernel_zs21:
  s_barrier
  s_waitcnt vmcnt(0)
  s_barrier
  s_add_u32 s81, s57, s79
  v_add_u32 v5, 0, v24
  ds_read_b128 v[32:35], v5 offset:0
  ds_read_b128 v[36:39], v5 offset:1024
  ds_read_b128 v[40:43], v5 offset:2048
  ds_read_b128 v[44:47], v5 offset:3072
  s_waitcnt lgkmcnt(3)
  buffer_store_dwordx4 v[32:35], v16, s[8:11], s81 offen sc1
  s_waitcnt lgkmcnt(2)
  buffer_store_dwordx4 v[36:39], v17, s[8:11], s81 offen sc1
  s_waitcnt lgkmcnt(1)
  buffer_store_dwordx4 v[40:43], v18, s[8:11], s81 offen sc1
  s_waitcnt lgkmcnt(0)
  buffer_store_dwordx4 v[44:47], v19, s[8:11], s81 offen sc1
  s_add_u32 s81, s80, 8192
  s_mov_b32 s78, s57
  s_add_u32 s74, s49, 1
  s_and_b32 s74, s74, 15
  s_waitcnt vmcnt(0)
  v_mov_b32 v5, 147456
  v_mov_b32 v6, 1
  v_cmp_eq_u32 vcc, 0, v1
  s_and_saveexec_b64 s[90:91], vcc
  ds_add_u32 v5, v6
  s_cmp_eq_u32 s50, 4
  s_cbranch_scc0 interleave_layers__ssm_conv_h3__linear_attn_block__prompt_kernel_lm22
  s_mov_b32 s61, 0
interleave_layers__ssm_conv_h3__linear_attn_block__prompt_kernel_l124:
  ds_read_b32 v7, v5
  s_add_u32 s61, s61, 1
  s_cmp_gt_u32 s61, 0x100000
  s_cbranch_scc1 interleave_layers__ssm_conv_h3__linear_attn_block__prompt_kernel_l1e25
  s_waitcnt lgkmcnt(0)
  v_cmp_ne_u32 vcc, 4, v7
  s_cbranch_vccnz interleave_layers__ssm_conv_h3__linear_attn_block__prompt_kernel_l124
interleave_layers__ssm_conv_h3__linear_attn_block__prompt_kernel_l1e25:
  s_add_u32 s62, s58, s81
  v_mov_b32 v11, s62
  buffer_atomic_add v6, v11, s[8:11], 0 offen sc1
  v_mov_b32 v5, s62
  s_mov_b32 s61, 0
interleave_layers__ssm_conv_h3__linear_attn_block__prompt_kernel_pw26:
  buffer_load_dword v8, v5, s[8:11], 0 offen sc1
  s_add_u32 s61, s61, 1
  s_cmp_gt_u32 s61, 0x40000
  s_cbranch_scc1 interleave_layers__ssm_conv_h3__linear_attn_block__prompt_kernel_pwe27
  s_waitcnt vmcnt(0)
  v_xor_b32 v8, 16, v8
  v_cmp_ne_u32 vcc, 0, v8
  s_cbranch_vccnz interleave_layers__ssm_conv_h3__linear_attn_block__prompt_kernel_pw26
interleave_layers__ssm_conv_h3__linear_attn_block__prompt_kernel_pwe27:
  v_mov_b32 v5, 147456
  v_mov_b32 v6, 1
  ds_write_b32 v5, v6 offset:4
  s_branch interleave_layers__ssm_conv_h3__linear_attn_block__prompt_kernel_ls23
interleave_layers__ssm_conv_h3__linear_attn_block__prompt_kernel_lm22:
  s_mov_b32 s61, 0
interleave_layers__ssm_conv_h3__linear_attn_block__prompt_kernel_l228:
  ds_read_b32 v7, v5 offset:4
  s_add_u32 s61, s61, 1
  s_cmp_gt_u32 s61, 0x400000
  s_cbranch_scc1 interleave_layers__ssm_conv_h3__linear_attn_block__prompt_kernel_ls23
  s_waitcnt lgkmcnt(0)
  v_cmp_ne_u32 vcc, 1, v7
  s_cbranch_vccnz interleave_layers__ssm_conv_h3__linear_attn_block__prompt_kernel_l228
interleave_layers__ssm_conv_h3__linear_attn_block__prompt_kernel_ls23:
  s_waitcnt lgkmcnt(0)
  s_mov_b64 exec, s[90:91]
  s_lshl_b32 s76, s74, 7
  s_add_u32 s76, s76, s78
  s_add_u32 m0, s71, 24576
  s_nop 0
  buffer_load_dwordx4 v16, s[8:11], s76 offen sc1 lds
  s_add_u32 m0, m0, 1024
  s_nop 0
  buffer_load_dwordx4 v17, s[8:11], s76 offen sc1 lds
  s_add_u32 m0, m0, 1024
  s_nop 0
  buffer_load_dwordx4 v18, s[8:11], s76 offen sc1 lds
  s_add_u32 m0, m0, 1024
  s_nop 0
  buffer_load_dwordx4 v19, s[8:11], s76 offen sc1 lds
  s_add_u32 s74, s74, 1
  s_and_b32 s74, s74, 15
  s_lshl_b32 s76, s74, 7
  s_add_u32 s76, s76, s78
  s_add_u32 m0, s71, 49152
  s_nop 0
  buffer_load_dwordx4 v16, s[8:11], s76 offen sc1 lds
  s_add_u32 m0, m0, 1024
  s_nop 0
  buffer_load_dwordx4 v17, s[8:11], s76 offen sc1 lds
  s_add_u32 m0, m0, 1024
  s_nop 0
  buffer_load_dwordx4 v18, s[8:11], s76 offen sc1 lds
  s_add_u32 m0, m0, 1024
  s_nop 0
  buffer_load_dwordx4 v19, s[8:11], s76 offen sc1 lds
  s_add_u32 s74, s74, 1
  s_and_b32 s74, s74, 15
  s_waitcnt vmcnt(4)
  s_barrier
  s_lshl_b32 s76, s74, 7
  s_add_u32 s76, s76, s78
  s_add_u32 m0, s71, 73728
  s_nop 0
  buffer_load_dwordx4 v16, s[8:11], s76 offen sc1 lds
  s_add_u32 m0, m0, 1024
  s_nop 0
  buffer_load_dwordx4 v17, s[8:11], s76 offen sc1 lds
  s_add_u32 m0, m0, 1024
  s_nop 0
  buffer_load_dwordx4 v18, s[8:11], s76 offen sc1 lds
  s_add_u32 m0, m0, 1024
  s_nop 0
  buffer_load_dwordx4 v19, s[8:11], s76 offen sc1 lds
  s_add_u32 s74, s74, 1
  s_and_b32 s74, s74, 15
  s_lshl_b32 s76, s74, 7
  s_add_u32 s76, s76, s78
  s_add_u32 m0, s71, 98304
  s_nop 0
  buffer_load_dwordx4 v16, s[8:11], s76 offen sc1 lds
  s_add_u32 m0, m0, 1024
  s_nop 0
  buffer_load_dwordx4 v17, s[8:11], s76 offen sc1 lds
  s_add_u32 m0, m0, 1024
  s_nop 0
  buffer_load_dwordx4 v18, s[8:11], s76 offen sc1 lds
  s_add_u32 m0, m0, 1024
  s_nop 0
  buffer_load_dwordx4 v19, s[8:11], s76 offen sc1 lds
  s_add_u32 s74, s74, 1
  s_and_b32 s74, s74, 15
  s_waitcnt vmcnt(8)
  s_barrier
  s_lshl_b32 s76, s74, 7
  s_add_u32 s76, s76, s78
  s_add_u32 m0, s71, 122880
  s_nop 0
  buffer_load_dwordx4 v16, s[8:11], s76 offen sc1 lds
  s_add_u32 m0, m0, 1024
  s_nop 0
  buffer_load_dwordx4 v17, s[8:11], s76 offen sc1 lds
  s_add_u32 m0, m0, 1024
  s_nop 0
  buffer_load_dwordx4 v18, s[8:11], s76 offen sc1 lds
  s_add_u32 m0, m0, 1024
  s_nop 0
  buffer_load_dwordx4 v19, s[8:11], s76 offen sc1 lds
  s_add_u32 s74, s74, 1
  s_and_b32 s74, s74, 15
  s_lshl_b32 s77, s75, 17
  s_add_u32 m0, s73, 122880
  s_nop 0
  buffer_load_dwordx4 v20, s[32:35], s77 offen lds
  s_add_u32 m0, m0, 1024
  s_nop 0
  buffer_load_dwordx4 v21, s[32:35], s77 offen lds
  s_add_u32 s75, s75, 1
  s_and_b32 s75, s75, 15
  s_waitcnt vmcnt(10)
  s_barrier
  s_lshl_b32 s76, s74, 7
  s_add_u32 s76, s76, s78
  s_add_u32 m0, s71, 0
  s_nop 0
  buffer_load_dwordx4 v16, s[8:11], s76 offen sc1 lds
  s_add_u32 m0, m0, 1024
  s_nop 0
  buffer_load_dwordx4 v17, s[8:11], s76 offen sc1 lds
  s_add_u32 m0, m0, 1024
  s_nop 0
  buffer_load_dwordx4 v18, s[8:11], s76 offen sc1 lds
  s_add_u32 m0, m0, 1024
  s_nop 0
  buffer_load_dwordx4 v19, s[8:11], s76 offen sc1 lds
  s_add_u32 s74, s74, 1
  s_and_b32 s74, s74, 15
  s_lshl_b32 s77, s75, 17
  s_add_u32 m0, s73, 0
  s_nop 0
  buffer_load_dwordx4 v20, s[32:35], s77 offen lds
  s_add_u32 m0, m0, 1024
  s_nop 0
  buffer_load_dwordx4 v21, s[32:35], s77 offen lds
  s_add_u32 s75, s75, 1
  s_and_b32 s75, s75, 15
  s_waitcnt vmcnt(12)
  s_barrier
  s_lshl_b32 s76, s74, 7
  s_add_u32 s76, s76, s78
  s_add_u32 m0, s71, 24576
  s_nop 0
  buffer_load_dwordx4 v16, s[8:11], s76 offen sc1 lds
  s_add_u32 m0, m0, 1024
  s_nop 0
  buffer_load_dwordx4 v17, s[8:11], s76 offen sc1 lds
  s_add_u32 m0, m0, 1024
  s_nop 0
  buffer_load_dwordx4 v18, s[8:11], s76 offen sc1 lds
  s_add_u32 m0, m0, 1024
  s_nop 0
  buffer_load_dwordx4 v19, s[8:11], s76 offen sc1 lds
  s_add_u32 s74, s74, 1
  s_and_b32 s74, s74, 15
  s_lshl_b32 s77, s75, 17
  s_add_u32 m0, s73, 24576
  s_nop 0
  buffer_load_dwordx4 v20, s[32:35], s77 offen lds
  s_add_u32 m0, m0, 1024
  s_nop 0
  buffer_load_dwordx4 v21, s[32:35], s77 offen lds
  s_add_u32 s75, s75, 1
  s_and_b32 s75, s75, 15
  s_waitcnt vmcnt(12)
  s_barrier
  s_lshl_b32 s76, s74, 7
  s_add_u32 s76, s76, s78
  s_add_u32 m0, s71, 49152
  s_nop 0
  buffer_load_dwordx4 v16, s[8:11], s76 offen sc1 lds
  s_add_u32 m0, m0, 1024
  s_nop 0
  buffer_load_dwordx4 v17, s[8:11], s76 offen sc1 lds
  s_add_u32 m0, m0, 1024
  s_nop 0
  buffer_load_dwordx4 v18, s[8:11], s76 offen sc1 lds
  s_add_u32 m0, m0, 1024
  s_nop 0
  buffer_load_dwordx4 v19, s[8:11], s76 offen sc1 lds
  s_add_u32 s74, s74, 1
  s_and_b32 s74, s74, 15
  s_lshl_b32 s77, s75, 17
  s_add_u32 m0, s73, 49152
  s_nop 0
  buffer_load_dwordx4 v20, s[32:35], s77 offen lds
  s_add_u32 m0, m0, 1024
  s_nop 0
  buffer_load_dwordx4 v21, s[32:35], s77 offen lds
  s_add_u32 s75, s75, 1
  s_and_b32 s75, s75, 15
  s_waitcnt vmcnt(12)
  s_barrier
  s_lshl_b32 s76, s74, 7
  s_add_u32 s76, s76, s78
  s_add_u32 m0, s71, 73728
  s_nop 0
  buffer_load_dwordx4 v16, s[8:11], s76 offen sc1 lds
  s_add_u32 m0, m0, 1024
  s_nop 0
  buffer_load_dwordx4 v17, s[8:11], s76 offen sc1 lds
  s_add_u32 m0, m0, 1024
  s_nop 0
  buffer_load_dwordx4 v18, s[8:11], s76 offen sc1 lds
  s_add_u32 m0, m0, 1024
  s_nop 0
  buffer_load_dwordx4 v19, s[8:11], s76 offen sc1 lds
  s_add_u32 s74, s74, 1
  s_and_b32 s74, s74, 15
  s_lshl_b32 s77, s75, 17
  s_add_u32 m0, s73, 73728
  s_nop 0
  buffer_load_dwordx4 v20, s[32:35], s77 offen lds
  s_add_u32 m0, m0, 1024
  s_nop 0
  buffer_load_dwordx4 v21, s[32:35], s77 offen lds
  s_add_u32 s75, s75, 1
  s_and_b32 s75, s75, 15
  s_waitcnt vmcnt(12)
  s_barrier
  s_lshl_b32 s76, s74, 7
  s_add_u32 s76, s76, s78
  s_add_u32 m0, s71, 98304
  s_nop 0
  buffer_load_dwordx4 v16, s[8:11], s76 offen sc1 lds
  s_add_u32 m0, m0, 1024
  s_nop 0
  buffer_load_dwordx4 v17, s[8:11], s76 offen sc1 lds
  s_add_u32 m0, m0, 1024
  s_nop 0
  buffer_load_dwordx4 v18, s[8:11], s76 offen sc1 lds
  s_add_u32 m0, m0, 1024
  s_nop 0
  buffer_load_dwordx4 v19, s[8:11], s76 offen sc1 lds
  s_add_u32 s74, s74, 1
  s_and_b32 s74, s74, 15
  s_lshl_b32 s77, s75, 17
  s_add_u32 m0, s73, 98304
  s_nop 0
  buffer_load_dwordx4 v20, s[32:35], s77 offen lds
  s_add_u32 m0, m0, 1024
  s_nop 0
  buffer_load_dwordx4 v21, s[32:35], s77 offen lds
  s_add_u32 s75, s75, 1
  s_and_b32 s75, s75, 15
  s_waitcnt vmcnt(12)
  s_barrier
  s_lshl_b32 s76, s74, 7
  s_add_u32 s76, s76, s78
  s_add_u32 m0, s71, 122880
  s_nop 0
  buffer_load_dwordx4 v16, s[8:11], s76 offen sc1 lds
  s_add_u32 m0, m0, 1024
  s_nop 0
  buffer_load_dwordx4 v17, s[8:11], s76 offen sc1 lds
  s_add_u32 m0, m0, 1024
  s_nop 0
  buffer_load_dwordx4 v18, s[8:11], s76 offen sc1 lds
  s_add_u32 m0, m0, 1024
  s_nop 0
  buffer_load_dwordx4 v19, s[8:11], s76 offen sc1 lds
  s_add_u32 s74, s74, 1
  s_and_b32 s74, s74, 15
  s_lshl_b32 s77, s75, 17
  s_add_u32 m0, s73, 122880
  s_nop 0
  buffer_load_dwordx4 v20, s[32:35], s77 offen lds
  s_add_u32 m0, m0, 1024
  s_nop 0
  buffer_load_dwordx4 v21, s[32:35], s77 offen lds
  s_add_u32 s75, s75, 1
  s_and_b32 s75, s75, 15
  s_waitcnt vmcnt(12)
  s_barrier
  s_lshl_b32 s76, s74, 7
  s_add_u32 s76, s76, s78
  s_add_u32 m0, s71, 0
  s_nop 0
  buffer_load_dwordx4 v16, s[8:11], s76 offen sc1 lds
  s_add_u32 m0, m0, 1024
  s_nop 0
  buffer_load_dwordx4 v17, s[8:11], s76 offen sc1 lds
  s_add_u32 m0, m0, 1024
  s_nop 0
  buffer_load_dwordx4 v18, s[8:11], s76 offen sc1 lds
  s_add_u32 m0, m0, 1024
  s_nop 0
  buffer_load_dwordx4 v19, s[8:11], s76 offen sc1 lds
  s_add_u32 s74, s74, 1
  s_and_b32 s74, s74, 15
  s_lshl_b32 s77, s75, 17
  s_add_u32 m0, s73, 0
  s_nop 0
  buffer_load_dwordx4 v20, s[32:35], s77 offen lds
  s_add_u32 m0, m0, 1024
  s_nop 0
  buffer_load_dwordx4 v21, s[32:35], s77 offen lds
  s_add_u32 s75, s75, 1
  s_and_b32 s75, s75, 15
  s_waitcnt vmcnt(12)
  s_barrier
  s_lshl_b32 s76, s74, 7
  s_add_u32 s76, s76, s78
  s_add_u32 m0, s71, 24576
  s_nop 0
  buffer_load_dwordx4 v16, s[8:11], s76 offen sc1 lds
  s_add_u32 m0, m0, 1024
  s_nop 0
  buffer_load_dwordx4 v17, s[8:11], s76 offen sc1 lds
  s_add_u32 m0, m0, 1024
  s_nop 0
  buffer_load_dwordx4 v18, s[8:11], s76 offen sc1 lds
  s_add_u32 m0, m0, 1024
  s_nop 0
  buffer_load_dwordx4 v19, s[8:11], s76 offen sc1 lds
  s_add_u32 s74, s74, 1
  s_and_b32 s74, s74, 15
  s_lshl_b32 s77, s75, 17
  s_add_u32 m0, s73, 24576
  s_nop 0
  buffer_load_dwordx4 v20, s[32:35], s77 offen lds
  s_add_u32 m0, m0, 1024
  s_nop 0
  buffer_load_dwordx4 v21, s[32:35], s77 offen lds
  s_add_u32 s75, s75, 1
  s_and_b32 s75, s75, 15
  s_waitcnt vmcnt(12)
  s_barrier
  s_lshl_b32 s76, s74, 7
  s_add_u32 s76, s76, s78
  s_add_u32 m0, s71, 49152
  s_nop 0
  buffer_load_dwordx4 v16, s[8:11], s76 offen sc1 lds
  s_add_u32 m0, m0, 1024
  s_nop 0
  buffer_load_dwordx4 v17, s[8:11], s76 offen sc1 lds
  s_add_u32 m0, m0, 1024
  s_nop 0
  buffer_load_dwordx4 v18, s[8:11], s76 offen sc1 lds
  s_add_u32 m0, m0, 1024
  s_nop 0
  buffer_load_dwordx4 v19, s[8:11], s76 offen sc1 lds
  s_add_u32 s74, s74, 1
  s_and_b32 s74, s74, 15
  s_lshl_b32 s77, s75, 17
  s_add_u32 m0, s73, 49152
  s_nop 0
  buffer_load_dwordx4 v20, s[32:35], s77 offen lds
  s_add_u32 m0, m0, 1024
  s_nop 0
  buffer_load_dwordx4 v21, s[32:35], s77 offen lds
  s_add_u32 s75, s75, 1
  s_and_b32 s75, s75, 15
  s_waitcnt vmcnt(12)
  s_barrier
  s_lshl_b32 s76, s74, 7
  s_add_u32 s76, s76, s78
  s_add_u32 m0, s71, 73728
  s_nop 0
  buffer_load_dwordx4 v16, s[8:11], s76 offen sc1 lds
  s_add_u32 m0, m0, 1024
  s_nop 0
  buffer_load_dwordx4 v17, s[8:11], s76 offen sc1 lds
  s_add_u32 m0, m0, 1024
  s_nop 0
  buffer_load_dwordx4 v18, s[8:11], s76 offen sc1 lds
  s_add_u32 m0, m0, 1024
  s_nop 0
  buffer_load_dwordx4 v19, s[8:11], s76 offen sc1 lds
  s_add_u32 s74, s74, 1
  s_and_b32 s74, s74, 15
  s_lshl_b32 s77, s75, 17
  s_add_u32 m0, s73, 73728
  s_nop 0
  buffer_load_dwordx4 v20, s[32:35], s77 offen lds
  s_add_u32 m0, m0, 1024
  s_nop 0
  buffer_load_dwordx4 v21, s[32:35], s77 offen lds
  s_add_u32 s75, s75, 1
  s_and_b32 s75, s75, 15
  s_waitcnt vmcnt(12)
  s_barrier
  s_waitcnt vmcnt(6)
  s_barrier
  s_waitcnt vmcnt(0)
  s_barrier
  s_barrier
  s_cmp_eq_u32 s53, 1
  s_cbranch_scc1 L_hfinal
  s_barrier
  s_cmp_ge_u32 s70, 2
  s_cbranch_scc1 interleave_layers__ssm_conv_h3__linear_attn_block__prompt_kernel_ss29
  s_lshl_b32 s60, s70, 9
  v_lshlrev_b32 v7, 3, v1
  v_add_u32 v6, s60, v7
  v_add_u32 v6, 57344, v6
  ds_read_b64 v[48:49], v6
  ds_read_b64 v[50:51], v6 offset:1024
  s_lshl_b32 s61, s48, 4
  s_add_u32 s61, s61, s49
  s_lshl_b32 s61, s61, 10
  s_add_u32 s60, s60, s61
  s_add_u32 s60, s60, 0x2000000
  s_waitcnt lgkmcnt(0)
  v_pk_add_f32 v[48:49], v[48:49], v[50:51]
  buffer_store_dwordx2 v[48:49], v7, s[8:11], s60 offen sc1
interleave_layers__ssm_conv_h3__linear_attn_block__prompt_kernel_ss29:
  s_waitcnt vmcnt(0)
  s_mov_b32 s81, 12288
  v_mov_b32 v5, 147464
  v_mov_b32 v6, 1
  v_cmp_eq_u32 vcc, 0, v1
  s_and_saveexec_b64 s[90:91], vcc
  ds_add_u32 v5, v6
  s_cmp_eq_u32 s50, 4
  s_cbranch_scc0 interleave_layers__ssm_conv_h3__linear_attn_block__prompt_kernel_lm30
  s_mov_b32 s61, 0
interleave_layers__ssm_conv_h3__linear_attn_block__prompt_kernel_l132:
  ds_read_b32 v7, v5
  s_add_u32 s61, s61, 1
  s_cmp_gt_u32 s61, 0x100000
  s_cbranch_scc1 interleave_layers__ssm_conv_h3__linear_attn_block__prompt_kernel_l1e33
  s_waitcnt lgkmcnt(0)
  v_cmp_ne_u32 vcc, 4, v7
  s_cbranch_vccnz interleave_layers__ssm_conv_h3__linear_attn_block__prompt_kernel_l132
interleave_layers__ssm_conv_h3__linear_attn_block__prompt_kernel_l1e33:
  s_add_u32 s62, s58, s81
  v_mov_b32 v11, s62
  buffer_atomic_add v6, v11, s[8:11], 0 offen sc1
  v_mov_b32 v5, s62
  s_mov_b32 s61, 0
interleave_layers__ssm_conv_h3__linear_attn_block__prompt_kernel_pw34:
  buffer_load_dword v8, v5, s[8:11], 0 offen sc1
  s_add_u32 s61, s61, 1
  s_cmp_gt_u32 s61, 0x40000
  s_cbranch_scc1 interleave_layers__ssm_conv_h3__linear_attn_block__prompt_kernel_pwe35
  s_waitcnt vmcnt(0)
  v_xor_b32 v8, 16, v8
  v_cmp_ne_u32 vcc, 0, v8
  s_cbranch_vccnz interleave_layers__ssm_conv_h3__linear_attn_block__prompt_kernel_pw34
interleave_layers__ssm_conv_h3__linear_attn_block__prompt_kernel_pwe35:
  v_mov_b32 v5, 147464
  v_mov_b32 v6, 1
  ds_write_b32 v5, v6 offset:4
  s_branch interleave_layers__ssm_conv_h3__linear_attn_block__prompt_kernel_ls31
interleave_layers__ssm_conv_h3__linear_attn_block__prompt_kernel_lm30:
  s_mov_b32 s61, 0
interleave_layers__ssm_conv_h3__linear_attn_block__prompt_kernel_l236:
  ds_read_b32 v7, v5 offset:4
  s_add_u32 s61, s61, 1
  s_cmp_gt_u32 s61, 0x400000
  s_cbranch_scc1 interleave_layers__ssm_conv_h3__linear_attn_block__prompt_kernel_ls31
  s_waitcnt lgkmcnt(0)
  v_cmp_ne_u32 vcc, 1, v7
  s_cbranch_vccnz interleave_layers__ssm_conv_h3__linear_attn_block__prompt_kernel_l236
interleave_layers__ssm_conv_h3__linear_attn_block__prompt_kernel_ls31:
  s_waitcnt lgkmcnt(0)
  s_mov_b64 exec, s[90:91]
  s_barrier
  s_mov_b32 s75, s49
  s_mul_i32 s77, s75, 393216
  s_add_u32 m0, s72, 81920
  s_nop 0
  buffer_load_dwordx4 v216, s[28:31], s77 offen lds
  s_add_u32 m0, m0, 1024
  s_nop 0
  buffer_load_dwordx4 v217, s[28:31], s77 offen lds
  s_add_u32 m0, m0, 1024
  s_nop 0
  buffer_load_dwordx4 v218, s[28:31], s77 offen lds
  s_add_u32 m0, m0, 1024
  s_nop 0
  buffer_load_dwordx4 v219, s[28:31], s77 offen lds
  s_add_u32 m0, m0, 1024
  s_nop 0
  buffer_load_dwordx4 v220, s[28:31], s77 offen lds
  s_add_u32 m0, m0, 1024
  s_nop 0
  buffer_load_dwordx4 v221, s[28:31], s77 offen lds
  s_add_u32 s75, s75, 1
  s_and_b32 s75, s75, 15
  s_mul_i32 s77, s75, 393216
  s_add_u32 m0, s72, 122880
  s_nop 0
  buffer_load_dwordx4 v216, s[28:31], s77 offen lds
  s_add_u32 m0, m0, 1024
  s_nop 0
  buffer_load_dwordx4 v217, s[28:31], s77 offen lds
  s_add_u32 m0, m0, 1024
  s_nop 0
  buffer_load_dwordx4 v218, s[28:31], s77 offen lds
  s_add_u32 m0, m0, 1024
  s_nop 0
  buffer_load_dwordx4 v219, s[28:31], s77 offen lds
  s_add_u32 m0, m0, 1024
  s_nop 0
  buffer_load_dwordx4 v220, s[28:31], s77 offen lds
  s_add_u32 m0, m0, 1024
  s_nop 0
  buffer_load_dwordx4 v221, s[28:31], s77 offen lds
  s_add_u32 s75, s75, 1
  s_and_b32 s75, s75, 15
  s_mul_i32 s77, s75, 393216
  s_add_u32 m0, s72, 0
  s_nop 0
  buffer_load_dwordx4 v216, s[28:31], s77 offen lds
  s_add_u32 m0, m0, 1024
  s_nop 0
  buffer_load_dwordx4 v217, s[28:31], s77 offen lds
  s_add_u32 m0, m0, 1024
  s_nop 0
  buffer_load_dwordx4 v218, s[28:31], s77 offen lds
  s_add_u32 m0, m0, 1024
  s_nop 0
  buffer_load_dwordx4 v219, s[28:31], s77 offen lds
  s_add_u32 m0, m0, 1024
  s_nop 0
  buffer_load_dwordx4 v220, s[28:31], s77 offen lds
  s_add_u32 m0, m0, 1024
  s_nop 0
  buffer_load_dwordx4 v221, s[28:31], s77 offen lds
  s_add_u32 s75, s75, 1
  s_and_b32 s75, s75, 15
  s_cmp_eq_u32 s50, 5
  s_cbranch_scc0 interleave_layers__ssm_conv_h3__linear_attn_block__prompt_kernel_zs37
  v_mov_b32 v5, 59392
  v_mov_b32 v8, 0
  v_mov_b32 v9, 0
  v_mov_b32 v10, 0
  v_mov_b32 v11, 0
  ds_write_b128 v5, v[8:11]
  s_waitcnt lgkmcnt(0)
interleave_layers__ssm_conv_h3__linear_attn_block__prompt_kernel_zs37:
  s_mov_b32 s53, 1
  s_mov_b32 s54, 0xc00000
  s_mov_b32 s55, 0x2100000
  s_mov_b32 s56, 0x1a00000
  s_mov_b32 s57, 0x1400000
  s_waitcnt vmcnt(0)
  s_branch L_hlayer
L_hfinal:
  s_barrier
  v_add_u32 v5, 81920, v24
  ds_read_b128 v[32:35], v5 offset:0
  ds_read_b128 v[36:39], v5 offset:1024
  ds_read_b128 v[40:43], v5 offset:2048
  ds_read_b128 v[44:47], v5 offset:3072
  s_waitcnt lgkmcnt(3)
  buffer_store_dwordx4 v[32:35], v16, s[36:39], s79 offen
  s_waitcnt lgkmcnt(2)
  buffer_store_dwordx4 v[36:39], v17, s[36:39], s79 offen
  s_waitcnt lgkmcnt(1)
  buffer_store_dwordx4 v[40:43], v18, s[36:39], s79 offen
  s_waitcnt lgkmcnt(0)
  buffer_store_dwordx4 v[44:47], v19, s[36:39], s79 offen
L_done:
  s_endpgm
.section .rodata,"a"
.p2align 6
.amdhsa_kernel interleave_layers__ssm_conv_h3__linear_attn_block__prompt_kernel
  .amdhsa_next_free_vgpr 256
  .amdhsa_next_free_sgpr 100
  .amdhsa_accum_offset 256
  .amdhsa_group_segment_fixed_size 0
  .amdhsa_kernarg_size 96
  .amdhsa_user_sgpr_count 2
  .amdhsa_user_sgpr_kernarg_segment_ptr 1
  .amdhsa_system_sgpr_workgroup_id_x 1
.end_amdhsa_kernel
```
